```python
import torch

def _softmax(x, axis=-1):
    return torch.softmax(x, dim=axis)
def _gelu(x):
    return torch.nn.functional.gelu(x, approximate="tanh")
def _silu(x):
    return torch.nn.functional.silu(x)
def _sigmoid(x):
    return torch.sigmoid(x)
def _layernorm(x, axis=-1, eps=1e-5):
    m = x.mean(dim=axis, keepdim=True)
    v = x.var(dim=axis, keepdim=True, unbiased=False)
    return (x - m) / torch.sqrt(v + eps)
def _scatter_add(tgt, idx, src, axis=0):
    return tgt.clone().index_add_(axis, idx, src)
def _segment_sum(src, seg, n):
    out = torch.zeros((n,) + src.shape[1:], dtype=src.dtype)
    return out.index_add_(0, seg, src)
def _pad(x, pw):
    flat = tuple(v for pair in reversed(pw) for v in pair)
    return torch.nn.functional.pad(x, flat)

kernel_name = 'recurrent_scan__ssm_conv_s4__glu_gated_glu__prompt'

def setup_inputs():

    _w = (lambda a: (lambda t: t.to(torch.bfloat16) if t.is_floating_point() else t)(torch.as_tensor(a)))
    def _A_setup():
        B, L, D, N = 1, 2048, 512, 128
        A_re = -(lambda _x: torch.exp(torch.as_tensor(_x)))((lambda *s: torch.randn(*s, dtype=torch.bfloat16) * 6.4)(D, N))
        A_im = torch.pi * (lambda *s: torch.randn(*s, dtype=torch.bfloat16) * 0.05)(D, N)
        B_re = (lambda *s: torch.randn(*s, dtype=torch.bfloat16) * 0.1)(D, N)
        B_im = (lambda *s: torch.randn(*s, dtype=torch.bfloat16) * 0.1)(D, N)
        C_re = (lambda *s: torch.randn(*s, dtype=torch.bfloat16) * 0.1)(D, N)
        C_im = (lambda *s: torch.randn(*s, dtype=torch.bfloat16) * 0.1)(D, N)
        log_dt = (lambda *s: torch.randn(*s, dtype=torch.bfloat16) * 0.05)(D) * 0.5 - 4.0
        Dskip = (lambda *s: torch.randn(*s, dtype=torch.bfloat16) * 0.05)(D)
        return {
            "u": _w((lambda *s: torch.randn(*s, dtype=torch.bfloat16) * 0.05)(B, L, D)),
            "A_re": _w(A_re),
            "A_im": _w(A_im),
            "B_re": _w(B_re),
            "B_im": _w(B_im),
            "C_re": _w(C_re),
            "C_im": _w(C_im),
            "log_dt": _w(log_dt),
            "Dskip": _w(Dskip),
        }
    _A_in = _A_setup()

    def _B_setup():
        B, S, D, F = 1, 2048, 512, 1376
        return {
            "x": _w((lambda *s: torch.randn(*s, dtype=torch.bfloat16) * 0.05)(B, S, D)),
            "w_gate": _w((lambda *s: torch.randn(*s, dtype=torch.bfloat16) * 0.05)(D, F)),
            "w_up": _w((lambda *s: torch.randn(*s, dtype=torch.bfloat16) * 0.05)(D, F)),
            "w_down": _w((lambda *s: torch.randn(*s, dtype=torch.bfloat16) * 0.05)(F, D)),
        }
    _B_in = _B_setup()

    return {
        "A_u": _A_in["u"],
        "A_A_re": _A_in["A_re"],
        "A_A_im": _A_in["A_im"],
        "A_B_re": _A_in["B_re"],
        "A_B_im": _A_in["B_im"],
        "A_C_re": _A_in["C_re"],
        "A_C_im": _A_in["C_im"],
        "A_log_dt": _A_in["log_dt"],
        "A_Dskip": _A_in["Dskip"],
        "B_x": _B_in["x"],
        "B_w_gate": _B_in["w_gate"],
        "B_w_up": _B_in["w_up"],
        "B_w_down": _B_in["w_down"],
    }

def reference(A_u, A_A_re, A_A_im, A_B_re, A_B_im, A_C_re, A_C_im, A_log_dt, A_Dskip, B_x, B_w_gate, B_w_up, B_w_down):
    def _A_ref(u, A_re, A_im, B_re, B_im, C_re, C_im, log_dt, Dskip):
        Bsz, L, D = u.shape
        dt = torch.exp(log_dt)[:, None]
        A = A_re + 1j * A_im
        Bc = B_re + 1j * B_im
        Cc = C_re + 1j * C_im
        logdA = dt * A
        dB = dt * Bc
        l = (lambda x, dt: x.to(dt))(torch.arange(L), A_re.dtype)
        P = torch.exp(logdA[:, :, None] * l[None, None, :])
        K = torch.einsum("dn,dnl,dn->dl", Cc, P, dB).real
        L2 = 2 * L
        Kp = _pad(K, ((0, 0), (0, L)))
        up = (lambda x, *d: x.permute(*d))(u, 0, 2, 1)
        up = _pad(up, ((0, 0), (0, 0), (0, L)))
        Kf = (lambda x, axes=(-2,-1): torch.fft.rfft2(x.float(), dim=axes))(Kp[:, None, :], axes=(-2, -1))
        Uf = (lambda x, axes=(-2,-1): torch.fft.rfft2(x.float(), dim=axes))(up[:, :, None, :], axes=(-2, -1))
        Yf = Uf * Kf[None, :, :, :]
        y = (lambda x, s, axes=(-2,-1): torch.fft.irfft2(x, s=s, dim=axes).to(torch.bfloat16))(Yf, (1, L2), axes=(-2, -1))[:, :, 0, :L]
        y = (lambda x, *d: x.permute(*d))(y, 0, 2, 1) + u * Dskip[None, None, :]
        return y

    def _B_ref(x, w_gate, w_up, w_down):
        g = torch.einsum("bsd,df->bsf", x, w_gate)
        u = torch.einsum("bsd,df->bsf", x, w_up)
        h = _sigmoid(g) * u
        return torch.einsum("bsf,fd->bsd", h, w_down)

    x = A_u
    xn = _layernorm(x, axis=-1)
    s = _A_ref(xn, A_A_re, A_A_im, A_B_re, A_B_im, A_C_re, A_C_im, A_log_dt, A_Dskip)
    g = _silu(_B_ref(xn, B_w_gate, B_w_up, B_w_down))
    return x + s * g
```

```asm
; @launch grid=(256,1,1) block=(512,1,1) lds=163840
.amdgcn_target "amdgcn-amd-amdhsa--gfx950"
.text
.globl recurrent_scan__ssm_conv_s4__glu_gated_glu__prompt_kernel
.p2align 8
.type recurrent_scan__ssm_conv_s4__glu_gated_glu__prompt_kernel,@function
recurrent_scan__ssm_conv_s4__glu_gated_glu__prompt_kernel:
    s_load_dwordx16 s[64:79], s[0:1], 0
    s_load_dwordx16 s[80:95], s[0:1], 64
    s_cmp_ge_u32 s2, 256
    s_cbranch_scc1 L_done
    s_getpc_b64 s[32:33]
L_pcref:
    s_lshr_b32 s49, s2, 3
    s_lshl_b32 s34, s49, 11
    v_lshl_add_u32 v2, v0, 2, s34
    v_min_u32 v2, L_codeend-L_pcref-4, v2
    global_load_dword v242, v2, s[32:33]
    v_lshrrev_b32 v2, 6, v0
    v_and_b32_e64 v1, 63, v0
    v_readfirstlane_b32 s3, v2
    v_and_b32 v2, 255, v0
    v_lshlrev_b32_e64 v2, 2, v2
    v_add_u32 v2, 162112, v2
    v_mov_b32_e64 v3, 1
    ds_write_b32 v2, v3
    s_and_b32 s48, s2, 7
    s_lshl_b32 s53, s48, 5
    s_add_u32 s53, s53, s49
    s_and_b32 s57, s3, 1
    s_and_b32 s34, s49, 3
    s_lshl_b32 s34, s34, 1
    s_add_u32 s34, s34, s57
    s_lshl_b32 s35, s48, 3
    s_add_u32 s34, s34, s35
    s_lshl_b32 s34, s34, 3
    s_lshr_b32 s35, s49, 2
    s_add_u32 s54, s34, s35
    s_lshr_b32 s36, s3, 1
    s_cmp_eq_u32 s36, 2
    s_cbranch_scc1 L_ld
    s_lshl_b32 s34, s54, 8
    s_lshl_b32 s35, s3, 5
    s_and_b32 s35, s35, 128
    s_add_u32 s34, s34, s35
    v_and_b32_e64 v3, 31, v0
    v_lshl_add_u32 v3, v3, 2, s34
    s_lshr_b32 s35, s54, 1
    s_lshl_b32 s35, s35, 2
    s_cmp_eq_u32 s36, 3
    s_cbranch_scc1 L_kg
    s_lshl_b32 s34, s53, 1
    s_add_u32 s34, s34, s57
    s_lshl_b32 s34, s34, 12
    v_lshl_add_u32 v2, v1, 4, s34
    s_waitcnt lgkmcnt(0)
    s_cmp_eq_u32 s36, 1
    s_cbranch_scc1 L_e1
    s_load_dword s100, s[78:79], s35
    s_load_dword s101, s[80:81], s35
    global_load_dword v226, v3, s[66:67]
    global_load_dword v227, v3, s[68:69]
    global_load_dword v228, v3, s[70:71]
    global_load_dword v229, v3, s[72:73]
    global_load_dword v230, v3, s[74:75]
    global_load_dword v231, v3, s[76:77]
    s_branch L_kg
L_e1:
    s_nop 0
    global_load_dwordx4 v[64:67], v2, s[64:65] offset:0
    global_load_dwordx4 v[68:71], v2, s[64:65] offset:1024
    global_load_dwordx4 v[72:75], v2, s[64:65] offset:2048
    global_load_dwordx4 v[76:79], v2, s[64:65] offset:3072
    s_branch L_g
L_ld:
    s_movk_i32 s36, 2752
    s_movk_i32 s37, 0x1556
    v_mul_u32_u24 v19, s37, v1
    v_lshrrev_b32_e64 v19, 16, v19
    v_mad_i32_i24 v21, v19, -12, v1
    v_mul_u32_u24_e64 v19, s36, v19
    v_lshl_add_u32 v8, v21, 4, v19
    v_add_u32 v18, 64, v1
    v_mul_u32_u24 v19, s37, v18
    v_lshrrev_b32_e64 v19, 16, v19
    v_mad_i32_i24 v22, v19, -12, v18
    v_lshrrev_b32 v20, 2, v19
    v_and_b32 v20, 2, v20
    v_xor_b32 v22, v22, v20
    v_mul_u32_u24 v19, s36, v19
    v_lshl_add_u32 v9, v22, 4, v19
    v_subrev_u32 v9, 1024, v9
    v_add_u32 v18, 128, v1
    v_mul_u32_u24 v19, s37, v18
    v_lshrrev_b32 v19, 16, v19
    v_mad_i32_i24 v23, v19, -12, v18
    v_lshrrev_b32 v20, 2, v19
    v_and_b32 v20, 2, v20
    v_xor_b32 v23, v23, v20
    v_mul_u32_u24 v19, s36, v19
    v_lshl_add_u32 v10, v23, 4, v19
    v_subrev_u32 v10, 2048, v10
    s_lshr_b32 s32, s48, 1
    s_and_b32 s33, s48, 1
    s_and_b32 s34, s49, 3
    s_lshr_b32 s35, s49, 2
    s_and_b32 s56, s49, 7
    s_lshr_b32 s55, s53, 3
    s_mul_i32 s52, s34, 0
    s_mul_i32 s51, s33, 7
    s_add_u32 s51, s51, s35
    s_lshl_b32 s36, s33, 1
    s_add_u32 s36, s36, s34
    s_cmp_ge_u32 s49, 28
    s_cselect_b32 s51, 14, s51
    s_cselect_b32 s34, s36, s34
    s_and_b32 s34, s34, 3
    s_lshl_b32 s50, s32, 2
    s_add_u32 s50, s50, s34
    s_nop 0
    s_bfe_u32 s58, s3, 0x10001
    s_mov_b32 s10, 0x200000
    s_mov_b32 s11, 0x20000
    s_cmp_eq_u32 s51, 14
    s_cselect_b32 s36, 3, 11
    v_mov_b32 v18, 0x7ff00000
    v_cmp_lt_u32 vcc, s36, v21
    s_nop 1
    v_cndmask_b32 v8, v8, v18, vcc
    v_cmp_lt_u32 vcc, s36, v22
    s_nop 1
    v_cndmask_b32 v9, v9, v18, vcc
    v_cmp_lt_u32 vcc, s36, v23
    s_nop 1
    v_cndmask_b32_e64 v10, v10, v18, vcc
    s_mov_b32 s14, 1409024
    s_mov_b32 s15, 0x20000
    s_mul_i32 s39, s51, 192
    s_mul_i32 s43, s57, 6176
    v_lshrrev_b32 v18, 3, v1
    v_lshlrev_b32 v18, 10, v18
    v_lshrrev_b32 v19, 4, v1
    v_and_b32 v20, 7, v1
    v_xor_b32_e64 v19, v19, v20
    v_lshl_add_u32 v12, v19, 4, v18
    v_xor_b32_e64 v13, 64, v12
    v_add_u32 v14, 14336, v12
    v_add_u32 v15, 21504, v13
    v_add_u32 v13, 7168, v13
    s_lshl_b32 s38, s50, 17
    s_lshl_b32 s36, s57, 16
    s_add_u32 s38, s38, s36
    s_lshl_b32 s44, s57, 13
    s_lshl_b32 s45, s57, 2
    s_add_u32 s45, s45, 162112
    s_add_u32 s40, s52, 0
    s_and_b32 s40, s40, 7
    s_mul_i32 s42, s40, 176128
    s_add_u32 s42, s42, s39
    s_lshl_b32 s41, s40, 7
    s_add_u32 s41, s41, s38
    s_cmp_eq_u32 s57, 0
    s_waitcnt lgkmcnt(0)
    s_cselect_b64 s[12:13], s[84:85], s[86:87]
    s_mov_b64 s[8:9], s[64:65]
    s_cmp_ge_u32 s49, 30
    s_cbranch_scc1 L_spare_ld
    s_add_u32 m0, s43, 0
    s_nop 0
    buffer_load_dwordx4 v8, s[12:15], s42 offen offset:0 lds
    buffer_load_dwordx4 v9, s[12:15], s42 offen offset:1024 lds
    buffer_load_dwordx4 v10, s[12:15], s42 offen offset:2048 lds
    s_add_u32 m0, s43, 3072
    s_add_u32 s42, s42, 44032
    buffer_load_dwordx4 v8, s[12:15], s42 offen offset:0 lds
    buffer_load_dwordx4 v9, s[12:15], s42 offen offset:1024 lds
    buffer_load_dwordx4 v10, s[12:15], s42 offen offset:2048 lds
    s_barrier
    s_add_u32 m0, s44, 61760
    s_nop 0
    buffer_load_dwordx4 v12, s[8:11], s41 offen offset:0 lds
    buffer_load_dwordx4 v13, s[8:11], s41 offen offset:1024 lds
    buffer_load_dwordx4 v14, s[8:11], s41 offen offset:2048 lds
    buffer_load_dwordx4 v15, s[8:11], s41 offen offset:3072 lds
    s_add_u32 m0, s44, 65856
    s_add_u32 s41, s41, 32768
    buffer_load_dwordx4 v12, s[8:11], s41 offen offset:0 lds
    buffer_load_dwordx4 v13, s[8:11], s41 offen offset:1024 lds
    buffer_load_dwordx4 v14, s[8:11], s41 offen offset:2048 lds
    buffer_load_dwordx4 v15, s[8:11], s41 offen offset:3072 lds
    s_mov_b64 s[8:9], s[64:65]
    s_mul_i32 s59, s57, 16896
    s_add_u32 s59, s59, 110912
    s_lshl_b32 s60, s57, 4
    s_add_u32 s60, s60, 144704
    s_mov_b64 s[20:21], s[88:89]
    s_mov_b32 s22, 1409024
    s_mov_b32 s23, 0x20000
    s_mov_b64 s[24:25], s[94:95]
    s_mov_b32 s26, 268435456
    s_mov_b32 s27, 0x20000
    s_mov_b64 s[28:29], s[90:91]
    s_nop 0
    s_mov_b32 s30, 2097152
    s_mov_b32 s31, 0x20000
    v_mov_b32 v252, 0x7ff00000
    v_mov_b32_e64 v253, 0
    s_mov_b32 m0, s45
    s_mov_b64 exec, 1
    buffer_load_dword v252, s[8:11], 0 offen offset:0 lds
    s_mov_b64 exec, -1
    s_nop 0
    s_add_u32 m0, s43, 12352
    s_add_u32 s42, s42, 44032
    buffer_load_dwordx4 v8, s[12:15], s42 offen offset:0 lds
    buffer_load_dwordx4 v9, s[12:15], s42 offen offset:1024 lds
    buffer_load_dwordx4 v10, s[12:15], s42 offen offset:2048 lds
    s_add_u32 m0, s43, 15424
    s_add_u32 s42, s42, 44032
    buffer_load_dwordx4 v8, s[12:15], s42 offen offset:0 lds
    buffer_load_dwordx4 v9, s[12:15], s42 offen offset:1024 lds
    buffer_load_dwordx4 v10, s[12:15], s42 offen offset:2048 lds
    s_mov_b32 m0, s45
    s_mov_b64 exec, 1
    buffer_load_dword v252, s[8:11], 0 offen offset:32 lds
    s_mov_b64 exec, -1
    s_add_u32 s40, s52, 1
    s_and_b32 s40, s40, 7
    s_mul_i32 s42, s40, 176128
    s_add_u32 s42, s42, s39
    s_lshl_b32 s41, s40, 7
    s_add_u32 s41, s41, s38
    s_add_u32 m0, s43, 24704
    s_nop 0
    s_nop 0
    buffer_load_dwordx4 v8, s[12:15], s42 offen offset:0 lds
    buffer_load_dwordx4 v9, s[12:15], s42 offen offset:1024 lds
    buffer_load_dwordx4 v10, s[12:15], s42 offen offset:2048 lds
    s_add_u32 m0, s43, 27776
    s_add_u32 s42, s42, 44032
    buffer_load_dwordx4 v8, s[12:15], s42 offen offset:0 lds
    s_waitcnt vmcnt(25)
    buffer_load_dwordx4 v9, s[12:15], s42 offen offset:1024 lds
    s_waitcnt vmcnt(25)
    buffer_load_dwordx4 v10, s[12:15], s42 offen offset:2048 lds
    s_waitcnt vmcnt(25)
    s_add_u32 m0, s44, 78144
    s_nop 0
    buffer_load_dwordx4 v12, s[8:11], s41 offen offset:0 lds
    s_waitcnt vmcnt(25)
    buffer_load_dwordx4 v13, s[8:11], s41 offen offset:1024 lds
    s_waitcnt vmcnt(25)
    buffer_load_dwordx4 v14, s[8:11], s41 offen offset:2048 lds
    s_waitcnt vmcnt(25)
    buffer_load_dwordx4 v15, s[8:11], s41 offen offset:3072 lds
    s_waitcnt vmcnt(25)
    s_add_u32 m0, s44, 82240
    s_add_u32 s41, s41, 32768
    buffer_load_dwordx4 v12, s[8:11], s41 offen offset:0 lds
    s_waitcnt vmcnt(25)
    buffer_load_dwordx4 v13, s[8:11], s41 offen offset:1024 lds
    s_waitcnt vmcnt(25)
    buffer_load_dwordx4 v14, s[8:11], s41 offen offset:2048 lds
    s_waitcnt vmcnt(25)
    buffer_load_dwordx4 v15, s[8:11], s41 offen offset:3072 lds
    s_mov_b32 m0, s45
    s_mov_b64 exec, 1
    buffer_load_dword v252, s[8:11], 0 offen offset:64 lds
    s_mov_b64 exec, -1
    v_lshlrev_b32_e64 v24, 7, v1
    s_lshl_b32 s32, s53, 1
    s_add_u32 s32, s32, s57
    s_mul_i32 s32, s32, 2816
    s_mov_b64 exec, 0x3fffff
    buffer_load_dword v26, v24, s[20:23], s32 offen
    s_mov_b64 exec, -1
    s_waitcnt vmcnt(25)
    s_add_u32 m0, s43, 37056
    s_add_u32 s42, s42, 44032
    buffer_load_dwordx4 v8, s[12:15], s42 offen offset:0 lds
    s_waitcnt vmcnt(25)
    buffer_load_dwordx4 v9, s[12:15], s42 offen offset:1024 lds
    s_waitcnt vmcnt(25)
    buffer_load_dwordx4 v10, s[12:15], s42 offen offset:2048 lds
    s_waitcnt vmcnt(25)
    s_nop 0
    s_add_u32 m0, s43, 40128
    s_add_u32 s42, s42, 44032
    buffer_load_dwordx4 v8, s[12:15], s42 offen offset:0 lds
    s_waitcnt vmcnt(25)
    buffer_load_dwordx4 v9, s[12:15], s42 offen offset:1024 lds
    s_waitcnt vmcnt(25)
    buffer_load_dwordx4 v10, s[12:15], s42 offen offset:2048 lds
    s_mov_b32 m0, s45
    s_mov_b64 exec, 1
    buffer_load_dword v252, s[8:11], 0 offen offset:96 lds
    s_mov_b64 exec, -1
    s_add_u32 s40, s52, 2
    s_and_b32 s40, s40, 7
    s_mul_i32 s42, s40, 176128
    s_add_u32 s42, s42, s39
    s_lshl_b32 s41, s40, 7
    s_add_u32 s41, s41, s38
    s_waitcnt vmcnt(25)
    s_add_u32 m0, s43, 49408
    s_nop 0
    buffer_load_dwordx4 v8, s[12:15], s42 offen offset:0 lds
    s_waitcnt vmcnt(25)
    buffer_load_dwordx4 v9, s[12:15], s42 offen offset:1024 lds
    s_waitcnt vmcnt(25)
    buffer_load_dwordx4 v10, s[12:15], s42 offen offset:2048 lds
    s_waitcnt vmcnt(25)
    s_nop 0
    s_add_u32 m0, s43, 52480
    s_add_u32 s42, s42, 44032
    buffer_load_dwordx4 v8, s[12:15], s42 offen offset:0 lds
    s_waitcnt vmcnt(25)
    buffer_load_dwordx4 v9, s[12:15], s42 offen offset:1024 lds
    s_waitcnt vmcnt(25)
    buffer_load_dwordx4 v10, s[12:15], s42 offen offset:2048 lds
    s_waitcnt vmcnt(25)
    s_add_u32 m0, s44, 94528
    s_nop 0
    buffer_load_dwordx4 v12, s[8:11], s41 offen offset:0 lds
    s_waitcnt vmcnt(25)
    buffer_load_dwordx4 v13, s[8:11], s41 offen offset:1024 lds
    s_waitcnt vmcnt(25)
    buffer_load_dwordx4 v14, s[8:11], s41 offen offset:2048 lds
    s_waitcnt vmcnt(25)
    buffer_load_dwordx4 v15, s[8:11], s41 offen offset:3072 lds
    s_waitcnt vmcnt(25)
    s_add_u32 m0, s44, 98624
    s_add_u32 s41, s41, 32768
    buffer_load_dwordx4 v12, s[8:11], s41 offen offset:0 lds
    s_waitcnt vmcnt(25)
    buffer_load_dwordx4 v13, s[8:11], s41 offen offset:1024 lds
    s_waitcnt vmcnt(25)
    buffer_load_dwordx4 v14, s[8:11], s41 offen offset:2048 lds
    s_waitcnt vmcnt(25)
    buffer_load_dwordx4 v15, s[8:11], s41 offen offset:3072 lds
    s_mov_b32 m0, s45
    s_mov_b64 exec, 1
    buffer_load_dword v252, s[8:11], 0 offen offset:128 lds
    s_mov_b64 exec, -1
    s_waitcnt vmcnt(25)
    s_nop 0
    s_add_u32 m0, s43, 127296
    s_add_u32 s42, s42, 44032
    buffer_load_dwordx4 v8, s[12:15], s42 offen offset:0 lds
    s_waitcnt vmcnt(25)
    buffer_load_dwordx4 v9, s[12:15], s42 offen offset:1024 lds
    s_waitcnt vmcnt(25)
    buffer_load_dwordx4 v10, s[12:15], s42 offen offset:2048 lds
    s_waitcnt vmcnt(25)
    s_nop 0
    s_add_u32 m0, s43, 130368
    s_add_u32 s42, s42, 44032
    buffer_load_dwordx4 v8, s[12:15], s42 offen offset:0 lds
    s_waitcnt vmcnt(25)
    buffer_load_dwordx4 v9, s[12:15], s42 offen offset:1024 lds
    s_waitcnt vmcnt(25)
    buffer_load_dwordx4 v10, s[12:15], s42 offen offset:2048 lds
    s_mov_b32 m0, s45
    s_mov_b64 exec, 1
    buffer_load_dword v252, s[8:11], 0 offen offset:160 lds
    s_mov_b64 exec, -1
    s_add_u32 s40, s52, 3
    s_and_b32 s40, s40, 7
    s_mul_i32 s42, s40, 176128
    s_add_u32 s42, s42, s39
    s_lshl_b32 s41, s40, 7
    s_add_u32 s41, s41, s38
    s_waitcnt vmcnt(25)
    s_add_u32 m0, s43, 139648
    s_nop 0
    buffer_load_dwordx4 v8, s[12:15], s42 offen offset:0 lds
    s_waitcnt vmcnt(25)
    buffer_load_dwordx4 v9, s[12:15], s42 offen offset:1024 lds
    s_waitcnt vmcnt(25)
    buffer_load_dwordx4 v10, s[12:15], s42 offen offset:2048 lds
    s_waitcnt vmcnt(25)
    s_nop 0
    s_add_u32 m0, s43, 142720
    s_add_u32 s42, s42, 44032
    buffer_load_dwordx4 v8, s[12:15], s42 offen offset:0 lds
    s_waitcnt vmcnt(25)
    buffer_load_dwordx4 v9, s[12:15], s42 offen offset:1024 lds
    s_waitcnt vmcnt(25)
    buffer_load_dwordx4 v10, s[12:15], s42 offen offset:2048 lds
    v_and_b32 v250, 1, v1
    v_lshlrev_b32 v250, 2, v250
    v_add_u32 v250, 163128, v250
    ds_read_b32 v251, v250
    s_waitcnt lgkmcnt(0)
    v_cmp_ne_u32_e64 vcc, 0, v251
    s_getpc_b64 s[62:63]
    s_cbranch_vccnz L_stub
    s_waitcnt vmcnt(25)
    s_add_u32 m0, s44, 110912
    s_nop 0
    buffer_load_dwordx4 v12, s[8:11], s41 offen offset:0 lds
    s_waitcnt vmcnt(25)
    buffer_load_dwordx4 v13, s[8:11], s41 offen offset:1024 lds
    s_waitcnt vmcnt(25)
    buffer_load_dwordx4 v14, s[8:11], s41 offen offset:2048 lds
    s_waitcnt vmcnt(25)
    buffer_load_dwordx4 v15, s[8:11], s41 offen offset:3072 lds
    s_waitcnt vmcnt(25)
    s_nop 0
    s_add_u32 m0, s44, 115008
    s_add_u32 s41, s41, 32768
    buffer_load_dwordx4 v12, s[8:11], s41 offen offset:0 lds
    s_waitcnt vmcnt(25)
    buffer_load_dwordx4 v13, s[8:11], s41 offen offset:1024 lds
    s_waitcnt vmcnt(25)
    buffer_load_dwordx4 v14, s[8:11], s41 offen offset:2048 lds
    s_waitcnt vmcnt(25)
    buffer_load_dwordx4 v15, s[8:11], s41 offen offset:3072 lds
    s_mov_b32 m0, s45
    s_mov_b64 exec, 1
    buffer_load_dword v252, s[8:11], 0 offen offset:192 lds
    s_mov_b64 exec, -1
    v_and_b32 v250, 3, v1
    v_lshlrev_b32 v250, 2, v250
    v_add_u32 v250, 162128, v250
    ds_read_b32 v251, v250
    s_waitcnt lgkmcnt(0)
    v_cmp_ne_u32 vcc, 0, v251
    s_getpc_b64 s[62:63]
    s_cbranch_vccnz L_stub
    s_waitcnt vmcnt(25)
    s_add_u32 m0, s43, 0
    s_add_u32 s42, s42, 44032
    buffer_load_dwordx4 v8, s[12:15], s42 offen offset:0 lds
    s_waitcnt vmcnt(25)
    buffer_load_dwordx4 v9, s[12:15], s42 offen offset:1024 lds
    s_waitcnt vmcnt(25)
    buffer_load_dwordx4 v10, s[12:15], s42 offen offset:2048 lds
    s_waitcnt vmcnt(25)
    s_nop 0
    s_add_u32 m0, s43, 3072
    s_add_u32 s42, s42, 44032
    buffer_load_dwordx4 v8, s[12:15], s42 offen offset:0 lds
    s_waitcnt vmcnt(25)
    buffer_load_dwordx4 v9, s[12:15], s42 offen offset:1024 lds
    s_waitcnt vmcnt(25)
    buffer_load_dwordx4 v10, s[12:15], s42 offen offset:2048 lds
    s_mov_b32 m0, s45
    s_mov_b64 exec, 1
    buffer_load_dword v252, s[8:11], 0 offen offset:224 lds
    s_mov_b64 exec, -1
    s_add_u32 s40, s52, 4
    s_and_b32 s40, s40, 7
    s_mul_i32 s42, s40, 176128
    s_add_u32 s42, s42, s39
    s_lshl_b32 s41, s40, 7
    s_add_u32 s41, s41, s38
    v_add_u32_e64 v250, 32, v250
    ds_read_b32 v251, v250
    s_waitcnt lgkmcnt(0)
    v_cmp_ne_u32_e64 vcc, 0, v251
    s_getpc_b64 s[62:63]
    s_cbranch_vccnz L_stub
    s_waitcnt vmcnt(25)
    s_add_u32 m0, s43, 12352
    s_nop 0
    buffer_load_dwordx4 v8, s[12:15], s42 offen offset:0 lds
    s_waitcnt vmcnt(25)
    buffer_load_dwordx4 v9, s[12:15], s42 offen offset:1024 lds
    s_waitcnt vmcnt(25)
    buffer_load_dwordx4 v10, s[12:15], s42 offen offset:2048 lds
    s_waitcnt vmcnt(25)
    s_add_u32 m0, s43, 15424
    s_add_u32 s42, s42, 44032
    buffer_load_dwordx4 v8, s[12:15], s42 offen offset:0 lds
    s_waitcnt vmcnt(25)
    buffer_load_dwordx4 v9, s[12:15], s42 offen offset:1024 lds
    s_waitcnt vmcnt(25)
    buffer_load_dwordx4 v10, s[12:15], s42 offen offset:2048 lds
    s_waitcnt vmcnt(25)
    s_add_u32 m0, s44, 61760
    s_nop 0
    buffer_load_dwordx4 v12, s[8:11], s41 offen offset:0 lds
    s_waitcnt vmcnt(25)
    buffer_load_dwordx4 v13, s[8:11], s41 offen offset:1024 lds
    s_waitcnt vmcnt(25)
    buffer_load_dwordx4 v14, s[8:11], s41 offen offset:2048 lds
    s_waitcnt vmcnt(25)
    buffer_load_dwordx4 v15, s[8:11], s41 offen offset:3072 lds
    s_waitcnt vmcnt(25)
    s_add_u32 m0, s44, 65856
    s_add_u32 s41, s41, 32768
    buffer_load_dwordx4 v12, s[8:11], s41 offen offset:0 lds
    s_waitcnt vmcnt(25)
    buffer_load_dwordx4 v13, s[8:11], s41 offen offset:1024 lds
    s_waitcnt vmcnt(25)
    buffer_load_dwordx4 v14, s[8:11], s41 offen offset:2048 lds
    s_waitcnt vmcnt(25)
    buffer_load_dwordx4 v15, s[8:11], s41 offen offset:3072 lds
    s_mov_b32 m0, s45
    s_mov_b64 exec, 1
    buffer_load_dword v252, s[8:11], 0 offen offset:256 lds
    s_mov_b64 exec, -1
    v_add_u32_e64 v250, 32, v250
    ds_read_b32 v251, v250
    s_waitcnt lgkmcnt(0)
    v_cmp_ne_u32_e64 vcc, 0, v251
    s_getpc_b64 s[62:63]
    s_cbranch_vccnz L_stub
    s_waitcnt vmcnt(25)
    s_add_u32 m0, s43, 24704
    s_add_u32 s42, s42, 44032
    buffer_load_dwordx4 v8, s[12:15], s42 offen offset:0 lds
    s_waitcnt vmcnt(25)
    buffer_load_dwordx4 v9, s[12:15], s42 offen offset:1024 lds
    s_waitcnt vmcnt(25)
    buffer_load_dwordx4 v10, s[12:15], s42 offen offset:2048 lds
    s_waitcnt vmcnt(25)
    s_nop 0
    s_add_u32 m0, s43, 27776
    s_add_u32 s42, s42, 44032
    buffer_load_dwordx4 v8, s[12:15], s42 offen offset:0 lds
    s_waitcnt vmcnt(25)
    buffer_load_dwordx4 v9, s[12:15], s42 offen offset:1024 lds
    s_waitcnt vmcnt(25)
    buffer_load_dwordx4 v10, s[12:15], s42 offen offset:2048 lds
    s_mov_b32 m0, s45
    s_mov_b64 exec, 1
    buffer_load_dword v252, s[8:11], 0 offen offset:288 lds
    s_mov_b64 exec, -1
    s_add_u32 s40, s52, 5
    s_and_b32 s40, s40, 7
    s_mul_i32 s42, s40, 176128
    s_add_u32 s42, s42, s39
    s_lshl_b32 s41, s40, 7
    s_add_u32 s41, s41, s38
    v_add_u32_e64 v250, 32, v250
    ds_read_b32 v251, v250
    s_waitcnt lgkmcnt(0)
    v_cmp_ne_u32_e64 vcc, 0, v251
    s_getpc_b64 s[62:63]
    s_cbranch_vccnz L_stub
    s_waitcnt vmcnt(25)
    s_add_u32 m0, s43, 37056
    s_nop 0
    buffer_load_dwordx4 v8, s[12:15], s42 offen offset:0 lds
    s_waitcnt vmcnt(25)
    buffer_load_dwordx4 v9, s[12:15], s42 offen offset:1024 lds
    s_waitcnt vmcnt(25)
    buffer_load_dwordx4 v10, s[12:15], s42 offen offset:2048 lds
    s_waitcnt vmcnt(25)
    s_add_u32 m0, s43, 40128
    s_add_u32 s42, s42, 44032
    buffer_load_dwordx4 v8, s[12:15], s42 offen offset:0 lds
    s_waitcnt vmcnt(25)
    buffer_load_dwordx4 v9, s[12:15], s42 offen offset:1024 lds
    s_waitcnt vmcnt(25)
    buffer_load_dwordx4 v10, s[12:15], s42 offen offset:2048 lds
    s_waitcnt vmcnt(25)
    s_add_u32 m0, s44, 78144
    s_nop 0
    buffer_load_dwordx4 v12, s[8:11], s41 offen offset:0 lds
    s_waitcnt vmcnt(25)
    buffer_load_dwordx4 v13, s[8:11], s41 offen offset:1024 lds
    s_waitcnt vmcnt(25)
    buffer_load_dwordx4 v14, s[8:11], s41 offen offset:2048 lds
    s_waitcnt vmcnt(25)
    buffer_load_dwordx4 v15, s[8:11], s41 offen offset:3072 lds
    s_waitcnt vmcnt(25)
    s_add_u32 m0, s44, 82240
    s_add_u32 s41, s41, 32768
    buffer_load_dwordx4 v12, s[8:11], s41 offen offset:0 lds
    s_waitcnt vmcnt(25)
    buffer_load_dwordx4 v13, s[8:11], s41 offen offset:1024 lds
    s_waitcnt vmcnt(25)
    buffer_load_dwordx4 v14, s[8:11], s41 offen offset:2048 lds
    s_waitcnt vmcnt(25)
    buffer_load_dwordx4 v15, s[8:11], s41 offen offset:3072 lds
    s_mov_b32 m0, s45
    s_mov_b64 exec, 1
    buffer_load_dword v252, s[8:11], 0 offen offset:320 lds
    s_mov_b64 exec, -1
    v_add_u32_e64 v250, 32, v250
    ds_read_b32 v251, v250
    s_waitcnt lgkmcnt(0)
    v_cmp_ne_u32_e64 vcc, 0, v251
    s_getpc_b64 s[62:63]
    s_cbranch_vccnz L_stub
    s_waitcnt vmcnt(25)
    s_add_u32 m0, s43, 49408
    s_add_u32 s42, s42, 44032
    buffer_load_dwordx4 v8, s[12:15], s42 offen offset:0 lds
    s_waitcnt vmcnt(25)
    buffer_load_dwordx4 v9, s[12:15], s42 offen offset:1024 lds
    s_waitcnt vmcnt(25)
    buffer_load_dwordx4 v10, s[12:15], s42 offen offset:2048 lds
    s_waitcnt vmcnt(25)
    s_nop 0
    s_add_u32 m0, s43, 52480
    s_add_u32 s42, s42, 44032
    buffer_load_dwordx4 v8, s[12:15], s42 offen offset:0 lds
    s_waitcnt vmcnt(25)
    buffer_load_dwordx4 v9, s[12:15], s42 offen offset:1024 lds
    s_waitcnt vmcnt(25)
    buffer_load_dwordx4 v10, s[12:15], s42 offen offset:2048 lds
    s_mov_b32 m0, s45
    s_mov_b64 exec, 1
    buffer_load_dword v252, s[8:11], 0 offen offset:352 lds
    s_mov_b64 exec, -1
    s_add_u32 s40, s52, 6
    s_and_b32 s40, s40, 7
    s_mul_i32 s42, s40, 176128
    s_add_u32 s42, s42, s39
    s_lshl_b32 s41, s40, 7
    s_add_u32 s41, s41, s38
    v_add_u32_e64 v250, 32, v250
    ds_read_b32 v251, v250
    s_waitcnt lgkmcnt(0)
    v_cmp_ne_u32_e64 vcc, 0, v251
    s_getpc_b64 s[62:63]
    s_cbranch_vccnz L_stub
    s_waitcnt vmcnt(25)
    s_add_u32 m0, s43, 127296
    s_nop 0
    buffer_load_dwordx4 v8, s[12:15], s42 offen offset:0 lds
    s_waitcnt vmcnt(25)
    buffer_load_dwordx4 v9, s[12:15], s42 offen offset:1024 lds
    s_waitcnt vmcnt(25)
    buffer_load_dwordx4 v10, s[12:15], s42 offen offset:2048 lds
    s_waitcnt vmcnt(25)
    s_add_u32 m0, s43, 130368
    s_add_u32 s42, s42, 44032
    buffer_load_dwordx4 v8, s[12:15], s42 offen offset:0 lds
    s_waitcnt vmcnt(25)
    buffer_load_dwordx4 v9, s[12:15], s42 offen offset:1024 lds
    s_waitcnt vmcnt(25)
    buffer_load_dwordx4 v10, s[12:15], s42 offen offset:2048 lds
    s_waitcnt vmcnt(25)
    s_add_u32 m0, s44, 94528
    s_nop 0
    buffer_load_dwordx4 v12, s[8:11], s41 offen offset:0 lds
    s_waitcnt vmcnt(25)
    buffer_load_dwordx4 v13, s[8:11], s41 offen offset:1024 lds
    s_waitcnt vmcnt(25)
    buffer_load_dwordx4 v14, s[8:11], s41 offen offset:2048 lds
    s_waitcnt vmcnt(25)
    buffer_load_dwordx4 v15, s[8:11], s41 offen offset:3072 lds
    s_waitcnt vmcnt(25)
    s_add_u32 m0, s44, 98624
    s_add_u32 s41, s41, 32768
    buffer_load_dwordx4 v12, s[8:11], s41 offen offset:0 lds
    s_waitcnt vmcnt(25)
    buffer_load_dwordx4 v13, s[8:11], s41 offen offset:1024 lds
    s_waitcnt vmcnt(25)
    buffer_load_dwordx4 v14, s[8:11], s41 offen offset:2048 lds
    s_waitcnt vmcnt(25)
    buffer_load_dwordx4 v15, s[8:11], s41 offen offset:3072 lds
    s_mov_b32 m0, s45
    s_mov_b64 exec, 1
    buffer_load_dword v252, s[8:11], 0 offen offset:384 lds
    s_mov_b64 exec, -1
    v_add_u32_e64 v250, 64, v250
    ds_read_b32 v251, v250
    s_waitcnt lgkmcnt(0)
    v_cmp_ne_u32 vcc, 0, v251
    s_getpc_b64 s[62:63]
    s_cbranch_vccnz L_stub
    s_waitcnt vmcnt(25)
    s_add_u32 m0, s43, 0
    s_add_u32 s42, s42, 44032
    buffer_load_dwordx4 v8, s[12:15], s42 offen offset:0 lds
    s_waitcnt vmcnt(25)
    buffer_load_dwordx4 v9, s[12:15], s42 offen offset:1024 lds
    s_waitcnt vmcnt(25)
    buffer_load_dwordx4 v10, s[12:15], s42 offen offset:2048 lds
    s_waitcnt vmcnt(25)
    s_nop 0
    s_add_u32 m0, s43, 3072
    s_add_u32 s42, s42, 44032
    buffer_load_dwordx4 v8, s[12:15], s42 offen offset:0 lds
    s_waitcnt vmcnt(25)
    buffer_load_dwordx4 v9, s[12:15], s42 offen offset:1024 lds
    s_waitcnt vmcnt(25)
    buffer_load_dwordx4 v10, s[12:15], s42 offen offset:2048 lds
    s_mov_b32 m0, s45
    s_mov_b64 exec, 1
    buffer_load_dword v252, s[8:11], 0 offen offset:416 lds
    s_mov_b64 exec, -1
    s_add_u32 s40, s52, 7
    s_and_b32 s40, s40, 7
    s_mul_i32 s42, s40, 176128
    s_add_u32 s42, s42, s39
    s_lshl_b32 s41, s40, 7
    s_add_u32 s41, s41, s38
    v_add_u32_e64 v250, 32, v250
    ds_read_b32 v251, v250
    s_waitcnt lgkmcnt(0)
    v_cmp_ne_u32_e64 vcc, 0, v251
    s_getpc_b64 s[62:63]
    s_cbranch_vccnz L_stub
    s_waitcnt vmcnt(25)
    s_add_u32 m0, s43, 12352
    s_nop 0
    buffer_load_dwordx4 v8, s[12:15], s42 offen offset:0 lds
    s_waitcnt vmcnt(25)
    buffer_load_dwordx4 v9, s[12:15], s42 offen offset:1024 lds
    s_waitcnt vmcnt(25)
    buffer_load_dwordx4 v10, s[12:15], s42 offen offset:2048 lds
    s_waitcnt vmcnt(25)
    s_add_u32 m0, s43, 15424
    s_add_u32 s42, s42, 44032
    buffer_load_dwordx4 v8, s[12:15], s42 offen offset:0 lds
    s_waitcnt vmcnt(25)
    buffer_load_dwordx4 v9, s[12:15], s42 offen offset:1024 lds
    s_waitcnt vmcnt(25)
    buffer_load_dwordx4 v10, s[12:15], s42 offen offset:2048 lds
    s_waitcnt vmcnt(25)
    s_add_u32 m0, s44, 110912
    s_nop 0
    buffer_load_dwordx4 v12, s[8:11], s41 offen offset:0 lds
    s_waitcnt vmcnt(25)
    buffer_load_dwordx4 v13, s[8:11], s41 offen offset:1024 lds
    s_waitcnt vmcnt(25)
    buffer_load_dwordx4 v14, s[8:11], s41 offen offset:2048 lds
    s_waitcnt vmcnt(25)
    buffer_load_dwordx4 v15, s[8:11], s41 offen offset:3072 lds
    s_waitcnt vmcnt(25)
    s_add_u32 m0, s44, 115008
    s_add_u32 s41, s41, 32768
    buffer_load_dwordx4 v12, s[8:11], s41 offen offset:0 lds
    s_waitcnt vmcnt(25)
    buffer_load_dwordx4 v13, s[8:11], s41 offen offset:1024 lds
    s_waitcnt vmcnt(25)
    buffer_load_dwordx4 v14, s[8:11], s41 offen offset:2048 lds
    s_waitcnt vmcnt(25)
    buffer_load_dwordx4 v15, s[8:11], s41 offen offset:3072 lds
    s_mov_b32 m0, s45
    s_mov_b64 exec, 1
    buffer_load_dword v252, s[8:11], 0 offen offset:448 lds
    s_mov_b64 exec, -1
    v_add_u32_e64 v250, 32, v250
    ds_read_b32 v251, v250
    s_waitcnt lgkmcnt(0)
    v_cmp_ne_u32_e64 vcc, 0, v251
    s_getpc_b64 s[62:63]
    s_cbranch_vccnz L_stub
    s_waitcnt vmcnt(25)
    s_add_u32 m0, s43, 24704
    s_add_u32 s42, s42, 44032
    buffer_load_dwordx4 v8, s[12:15], s42 offen offset:0 lds
    s_waitcnt vmcnt(25)
    buffer_load_dwordx4 v9, s[12:15], s42 offen offset:1024 lds
    s_waitcnt vmcnt(25)
    buffer_load_dwordx4 v10, s[12:15], s42 offen offset:2048 lds
    s_waitcnt vmcnt(25)
    s_nop 0
    s_add_u32 m0, s43, 27776
    s_add_u32 s42, s42, 44032
    buffer_load_dwordx4 v8, s[12:15], s42 offen offset:0 lds
    s_waitcnt vmcnt(25)
    buffer_load_dwordx4 v9, s[12:15], s42 offen offset:1024 lds
    s_waitcnt vmcnt(25)
    buffer_load_dwordx4 v10, s[12:15], s42 offen offset:2048 lds
    s_mov_b32 m0, s45
    s_mov_b64 exec, 1
    buffer_load_dword v252, s[8:11], 0 offen offset:480 lds
    s_mov_b64 exec, -1
L_fetch:
    v_lshrrev_b32 v8, 2, v1
    v_mul_u32_u24 v8, 8320, v8
    v_and_b32_e64 v9, 3, v1
    v_lshl_add_u32 v8, v9, 4, v8
    v_lshrrev_b32_e64 v10, 1, v1
    v_mul_u32_u24 v10, 8320, v10
    v_lshrrev_b32 v9, 4, v1
    v_xor_b32 v9, v9, v1
    v_and_b32_e64 v9, 1, v9
    v_lshl_add_u32 v10, v9, 4, v10
    v_lshrrev_b32 v9, 1, v1
    v_add_u32 v9, s48, v9
    v_and_b32 v9, 7, v9
    v_cmp_eq_u32 vcc, 3, v9
    v_lshrrev_b32 v9, 4, v1
    v_lshlrev_b32 v9, 7, v9
    v_add_u32 v9, 20971648, v9
    v_add_u32 v9, v9, v10
    v_cndmask_b32 v10, v10, v9, vcc
    s_mul_i32 s34, s50, 133120
    s_add_u32 s34, s34, 1056768
    s_and_b32 s32, s54, 7
    s_lshl_b32 s32, s32, 10
    s_lshr_b32 s33, s54, 4
    s_lshl_b32 s33, s33, 5
    s_add_u32 s32, s32, s33
    s_mul_i32 s33, s57, 1064960
    s_add_u32 s32, s32, s33
    s_add_u32 s32, s32, 1048576
    s_lshl_b32 s33, s57, 12
    s_nop 0
    s_add_u32 s33, s33, 145728
    v_mov_b32 v250, 162920
    ds_read_b32 v251, v250
    s_waitcnt lgkmcnt(0)
    v_cmp_ne_u32 vcc, 0, v251
    s_getpc_b64 s[62:63]
    s_cbranch_vccnz L_stub
    s_cmp_eq_u32 s57, 1
    s_cbranch_scc1 L_nost
    s_mov_b32 m0, 158016
    s_nop 0
    buffer_load_dwordx4 v8, s[24:27], s34 offen sc1 lds
    s_mov_b32 m0, 162916
    s_mov_b64 exec, 1
    buffer_load_dword v252, s[8:11], 0 offen offset:0 lds
    s_mov_b64 exec, -1
L_nost:
    s_add_u32 m0, s33, 0
    s_nop 0
    s_nop 0
    buffer_load_dwordx4 v10, s[24:27], s32 offen sc1 lds
    s_add_u32 m0, s33, 1024
    s_add_u32 s32, s32, 266240
    buffer_load_dwordx4 v10, s[24:27], s32 offen sc1 lds
    s_add_u32 m0, s33, 2048
    s_add_u32 s32, s32, 266240
    buffer_load_dwordx4 v10, s[24:27], s32 offen sc1 lds
    s_add_u32 m0, s33, 3072
    s_add_u32 s32, s32, 266240
    buffer_load_dwordx4 v10, s[24:27], s32 offen sc1 lds
    s_lshl_b32 s33, s57, 2
    s_add_u32 m0, s33, 162888
    s_mov_b64 exec, 1
    buffer_load_dword v252, s[8:11], 0 offen offset:0 lds
    s_mov_b64 exec, -1
    v_and_b32 v10, 3, v1
    v_sub_u32_e64 v10, 3, v10
    v_mul_u32_u24 v10, 4160, v10
    v_bfe_u32 v11, v1, 2, 2
    v_lshlrev_b32 v11, 3, v11
    v_sub_u32 v10, v10, v11
    v_and_b32_e64 v12, 48, v1
    s_lshl_b32 s32, s58, 8
    s_sub_u32 s33, s59, s32
    s_add_u32 s33, s33, 280
    v_add3_u32 v8, v10, v12, s33
    v_and_b32 v10, 15, v1
    v_lshrrev_b32 v11, 4, v1
    v_lshl_add_u32 v10, v10, 1, v11
    s_lshl_b32 s32, s58, 4
    s_sub_u32 s32, 30, s32
    v_add_u32_e64 v10, s32, v10
    v_bfe_u32 v11, v10, 3, 1
    v_xor_b32_e64 v11, s57, v11
    v_lshl_add_u32 v11, v10, 1, v11
    v_lshlrev_b32_e64 v11, 4, v11
    v_add_u32 v4, 144704, v11
    v_subrev_u32_e64 v10, 4, v10
    v_bfe_u32 v11, v10, 3, 1
    v_xor_b32_e64 v11, s57, v11
    v_lshl_add_u32 v11, v10, 1, v11
    v_lshlrev_b32_e64 v11, 4, v11
    v_add_u32 v5, 144704, v11
    v_subrev_u32_e64 v10, 4, v10
    v_bfe_u32 v11, v10, 3, 1
    v_xor_b32_e64 v11, s57, v11
    v_lshl_add_u32 v11, v10, 1, v11
    v_lshlrev_b32_e64 v11, 4, v11
    v_add_u32 v6, 144704, v11
    v_subrev_u32_e64 v10, 4, v10
    v_bfe_u32 v11, v10, 3, 1
    v_xor_b32_e64 v11, s57, v11
    v_lshl_add_u32 v11, v10, 1, v11
    v_lshlrev_b32_e64 v11, 4, v11
    v_add_u32 v7, 144704, v11
    v_lshrrev_b32 v12, 3, v1
    v_lshlrev_b32 v12, 10, v12
    v_lshrrev_b32 v13, 2, v1
    v_and_b32 v13, 4, v13
    v_and_b32 v14, 7, v1
    v_xor_b32 v13, v13, v14
    v_lshl_add_u32 v22, v13, 4, v12
    v_add_u32 v23, 7168, v22
    s_lshl_b32 s40, s56, 7
    s_lshl_b32 s41, s57, 13
    s_add_u32 s40, s40, s41
    s_add_u32 s42, s40, 704512
    s_lshl_b32 s41, s57, 10
    v_and_b32 v250, 3, v1
    v_lshlrev_b32 v250, 2, v250
    v_add_u32 v250, 162416, v250
    ds_read_b32 v251, v250
    s_waitcnt lgkmcnt(0)
    v_cmp_ne_u32 vcc, 0, v251
    s_getpc_b64 s[62:63]
    s_cbranch_vccnz L_stub
    s_add_u32 m0, s41, 65536
    s_nop 0
    buffer_load_dwordx4 v22, s[20:23], s40 offen lds
    s_add_u32 m0, s41, 67584
    s_nop 0
    buffer_load_dwordx4 v22, s[20:23], s42 offen lds
    s_add_u32 m0, s41, 69632
    s_add_u32 s40, s40, 16384
    buffer_load_dwordx4 v22, s[20:23], s40 offen lds
    s_add_u32 m0, s41, 71680
    s_add_u32 s42, s42, 16384
    buffer_load_dwordx4 v22, s[20:23], s42 offen lds
    s_add_u32 m0, s41, 73728
    s_add_u32 s40, s40, 16384
    buffer_load_dwordx4 v22, s[20:23], s40 offen lds
    s_add_u32 m0, s41, 75776
    s_add_u32 s42, s42, 16384
    buffer_load_dwordx4 v22, s[20:23], s42 offen lds
    v_and_b32 v250, 3, v1
    v_lshlrev_b32 v250, 2, v250
    v_add_u32 v250, 162448, v250
    ds_read_b32 v251, v250
    s_waitcnt lgkmcnt(0)
    v_cmp_ne_u32 vcc, 0, v251
    s_getpc_b64 s[62:63]
    s_cbranch_vccnz L_stub
    s_add_u32 m0, s41, 40960
    s_add_u32 s40, s40, 16384
    buffer_load_dwordx4 v22, s[20:23], s40 offen lds
    s_add_u32 m0, s41, 43008
    s_add_u32 s42, s42, 16384
    buffer_load_dwordx4 v22, s[20:23], s42 offen lds
    s_add_u32 m0, s41, 45056
    s_add_u32 s40, s40, 16384
    buffer_load_dwordx4 v22, s[20:23], s40 offen lds
    s_add_u32 m0, s41, 47104
    s_add_u32 s42, s42, 16384
    buffer_load_dwordx4 v22, s[20:23], s42 offen lds
    v_and_b32 v250, 3, v1
    v_lshlrev_b32 v250, 2, v250
    v_add_u32 v250, 162480, v250
    ds_read_b32 v251, v250
    s_waitcnt lgkmcnt(0)
    v_cmp_ne_u32 vcc, 0, v251
    s_getpc_b64 s[62:63]
    s_cbranch_vccnz L_stub
    s_add_u32 m0, s41, 49152
    s_add_u32 s40, s40, 16384
    buffer_load_dwordx4 v22, s[20:23], s40 offen lds
    s_add_u32 m0, s41, 51200
    s_add_u32 s42, s42, 16384
    buffer_load_dwordx4 v22, s[20:23], s42 offen lds
    s_add_u32 m0, s41, 53248
    s_add_u32 s40, s40, 16384
    buffer_load_dwordx4 v22, s[20:23], s40 offen lds
    s_add_u32 m0, s41, 55296
    s_add_u32 s42, s42, 16384
    buffer_load_dwordx4 v22, s[20:23], s42 offen lds
    s_add_u32 m0, s41, 57344
    s_add_u32 s40, s40, 16384
    buffer_load_dwordx4 v22, s[20:23], s40 offen lds
    s_add_u32 m0, s41, 59392
    s_add_u32 s42, s42, 16384
    buffer_load_dwordx4 v22, s[20:23], s42 offen lds
    s_waitcnt vmcnt(15)
    s_nop 0
    s_add_u32 m0, s41, 61440
    s_add_u32 s40, s40, 16384
    buffer_load_dwordx4 v22, s[20:23], s40 offen lds
    s_waitcnt vmcnt(15)
    s_nop 0
    s_add_u32 m0, s41, 63488
    s_add_u32 s42, s42, 16384
    buffer_load_dwordx4 v22, s[20:23], s42 offen lds
    s_waitcnt vmcnt(15)
    s_nop 0
    s_add_u32 m0, s41, 77824
    s_add_u32 s40, s40, 16384
    buffer_load_dwordx4 v22, s[20:23], s40 offen lds
    s_waitcnt vmcnt(15)
    s_nop 0
    s_add_u32 m0, s41, 79872
    s_add_u32 s42, s42, 16384
    buffer_load_dwordx4 v22, s[20:23], s42 offen lds
    s_waitcnt vmcnt(15)
    s_nop 0
    s_add_u32 m0, s41, 81920
    s_add_u32 s40, s40, 16384
    buffer_load_dwordx4 v22, s[20:23], s40 offen lds
    s_waitcnt vmcnt(15)
    s_nop 0
    s_add_u32 m0, s41, 83968
    s_add_u32 s42, s42, 16384
    buffer_load_dwordx4 v22, s[20:23], s42 offen lds
    s_waitcnt vmcnt(15)
    s_nop 0
    s_add_u32 m0, s41, 86016
    s_add_u32 s40, s40, 16384
    buffer_load_dwordx4 v22, s[20:23], s40 offen lds
    s_waitcnt vmcnt(15)
    s_nop 0
    s_add_u32 m0, s41, 88064
    s_add_u32 s42, s42, 16384
    buffer_load_dwordx4 v22, s[20:23], s42 offen lds
    s_waitcnt vmcnt(15)
    s_nop 0
    s_add_u32 m0, s41, 90112
    s_add_u32 s40, s40, 16384
    buffer_load_dwordx4 v22, s[20:23], s40 offen lds
    s_waitcnt vmcnt(15)
    s_nop 0
    s_add_u32 m0, s41, 92160
    s_add_u32 s42, s42, 16384
    buffer_load_dwordx4 v22, s[20:23], s42 offen lds
    v_and_b32 v250, 3, v1
    v_lshlrev_b32 v250, 2, v250
    v_add_u32 v250, 162544, v250
    ds_read_b32 v251, v250
    s_waitcnt lgkmcnt(0)
    v_cmp_ne_u32 vcc, 0, v251
    s_getpc_b64 s[62:63]
    s_cbranch_vccnz L_stub
    s_waitcnt vmcnt(15)
    s_add_u32 m0, s41, 0
    s_add_u32 s40, s40, 16384
    buffer_load_dwordx4 v22, s[20:23], s40 offen lds
    s_waitcnt vmcnt(15)
    s_nop 0
    s_add_u32 m0, s41, 2048
    s_add_u32 s42, s42, 16384
    buffer_load_dwordx4 v22, s[20:23], s42 offen lds
    s_waitcnt vmcnt(15)
    s_nop 0
    s_add_u32 m0, s41, 4096
    s_add_u32 s40, s40, 16384
    buffer_load_dwordx4 v22, s[20:23], s40 offen lds
    s_waitcnt vmcnt(15)
    s_nop 0
    s_add_u32 m0, s41, 6144
    s_add_u32 s42, s42, 16384
    buffer_load_dwordx4 v22, s[20:23], s42 offen lds
    s_waitcnt vmcnt(15)
    s_nop 0
    s_add_u32 m0, s41, 8192
    s_add_u32 s40, s40, 16384
    buffer_load_dwordx4 v22, s[20:23], s40 offen lds
    s_waitcnt vmcnt(15)
    s_nop 0
    s_add_u32 m0, s41, 10240
    s_add_u32 s42, s42, 16384
    buffer_load_dwordx4 v22, s[20:23], s42 offen lds
    s_lshl_b32 s33, s57, 2
    s_add_u32 m0, s33, 162928
    s_mov_b64 exec, 1
    buffer_load_dword v252, s[8:11], 0 offen offset:0 lds
    s_mov_b64 exec, -1
L_conv:
    s_and_b32 s38, s3, 3
    s_lshl_b32 s38, s38, 2
    s_add_u32 s38, s38, 162768
    v_and_b32 v250, 3, v1
    v_lshlrev_b32_e64 v250, 2, v250
    v_add_u32 v250, 162880, v250
    ds_read_b32 v251, v250
    s_waitcnt lgkmcnt(0)
    v_cmp_ne_u32 vcc, 0, v251
    s_getpc_b64 s[62:63]
    s_cbranch_vccnz L_stub
    v_and_b32 v250, 3, v1
    v_lshlrev_b32 v250, 2, v250
    v_add_u32 v250, 162640, v250
    s_setprio 1
    s_nop 0
    ds_read_b128 v[96:99], v4 offset:0
    ds_read_b64 v[64:65], v8 offset:3776
    ds_read_b64 v[66:67], v8 offset:3784
    ds_read_b128 v[100:103], v4 offset:1024
    ds_read_b64 v[68:69], v8 offset:3264
    ds_read_b64 v[70:71], v8 offset:3272
    ds_read_b128 v[104:107], v4 offset:2048
    ds_read_b64 v[72:73], v8 offset:2752
    ds_read_b64 v[74:75], v8 offset:2760
    ds_read_b128 v[108:111], v4 offset:3072
    ds_read_b64 v[76:77], v8 offset:2240
    ds_read_b64 v[78:79], v8 offset:2248
    ds_read_b128 v[112:115], v4 offset:4096
    ds_read_b64 v[80:81], v8 offset:1728
    ds_read_b64 v[82:83], v8 offset:1736
    ds_read_b128 v[116:119], v4 offset:5120
    ds_read_b64 v[84:85], v8 offset:1216
    ds_read_b64 v[86:87], v8 offset:1224
    ds_read_b128 v[120:123], v4 offset:6144
    ds_read_b64 v[88:89], v8 offset:704
    ds_read_b64 v[90:91], v8 offset:712
    ds_read_b128 v[124:127], v4 offset:7168
    ds_read_b64 v[92:93], v8 offset:192
    ds_read_b64 v[94:95], v8 offset:200
    ds_read_b32 v251, v250
    s_waitcnt lgkmcnt(0)
    v_cmp_ne_u32 vcc, 0, v251
    s_getpc_b64 s[62:63]
    s_cbranch_vccnz L_stub
    v_mfma_f32_16x16x32_bf16 v[32:35], v[64:67], v[96:99], 0
    ds_read_b128 v[160:163], v5 offset:0
    v_mfma_f32_16x16x32_bf16 v[36:39], v[64:67], v[100:103], 0
    ds_read_b64 v[128:129], v8 offset:3712
    v_mfma_f32_16x16x32_bf16 v[36:39], v[68:71], v[96:99], v[36:39]
    ds_read_b64 v[130:131], v8 offset:3720
    v_mfma_f32_16x16x32_bf16 v[40:43], v[68:71], v[100:103], 0
    ds_read_b128 v[164:167], v5 offset:1024
    v_mfma_f32_16x16x32_bf16 v[40:43], v[64:67], v[104:107], v[40:43]
    ds_read_b64 v[132:133], v8 offset:3200
    v_mfma_f32_16x16x32_bf16 v[40:43], v[72:75], v[96:99], v[40:43]
    ds_read_b64 v[134:135], v8 offset:3208
    v_mfma_f32_16x16x32_bf16 v[44:47], v[68:71], v[104:107], 0
    ds_read_b128 v[168:171], v5 offset:2048
    v_mfma_f32_16x16x32_bf16 v[44:47], v[72:75], v[100:103], v[44:47]
    ds_read_b64 v[136:137], v8 offset:2688
    v_mfma_f32_16x16x32_bf16 v[48:51], v[72:75], v[104:107], 0
    ds_read_b64 v[138:139], v8 offset:2696
    v_mfma_f32_16x16x32_bf16 v[44:47], v[64:67], v[108:111], v[44:47]
    ds_read_b128 v[172:175], v5 offset:3072
    v_mfma_f32_16x16x32_bf16 v[44:47], v[76:79], v[96:99], v[44:47]
    ds_read_b64 v[140:141], v8 offset:2176
    v_mfma_f32_16x16x32_bf16 v[48:51], v[68:71], v[108:111], v[48:51]
    ds_read_b64 v[142:143], v8 offset:2184
    v_mfma_f32_16x16x32_bf16 v[48:51], v[76:79], v[100:103], v[48:51]
    ds_read_b128 v[176:179], v5 offset:4096
    v_mfma_f32_16x16x32_bf16 v[52:55], v[72:75], v[108:111], 0
    ds_read_b64 v[144:145], v8 offset:1664
    v_mfma_f32_16x16x32_bf16 v[52:55], v[76:79], v[104:107], v[52:55]
    ds_read_b64 v[146:147], v8 offset:1672
    v_mfma_f32_16x16x32_bf16 v[56:59], v[76:79], v[108:111], 0
    ds_read_b128 v[180:183], v5 offset:5120
    v_mfma_f32_16x16x32_bf16 v[48:51], v[64:67], v[112:115], v[48:51]
    ds_read_b64 v[148:149], v8 offset:1152
    v_mfma_f32_16x16x32_bf16 v[48:51], v[80:83], v[96:99], v[48:51]
    ds_read_b64 v[150:151], v8 offset:1160
    v_mfma_f32_16x16x32_bf16 v[52:55], v[68:71], v[112:115], v[52:55]
    ds_read_b128 v[184:187], v5 offset:6144
    v_mfma_f32_16x16x32_bf16 v[52:55], v[80:83], v[100:103], v[52:55]
    ds_read_b64 v[152:153], v8 offset:640
    v_mfma_f32_16x16x32_bf16 v[56:59], v[72:75], v[112:115], v[56:59]
    ds_read_b64 v[154:155], v8 offset:648
    v_mfma_f32_16x16x32_bf16 v[56:59], v[80:83], v[104:107], v[56:59]
    ds_read_b128 v[188:191], v5 offset:7168
    v_mfma_f32_16x16x32_bf16 v[60:63], v[76:79], v[112:115], 0
    ds_read_b64 v[156:157], v8 offset:128
    v_mfma_f32_16x16x32_bf16 v[60:63], v[80:83], v[108:111], v[60:63]
    ds_read_b64 v[158:159], v8 offset:136
    v_mfma_f32_16x16x32_bf16 v[52:55], v[64:67], v[116:119], v[52:55]
    v_mfma_f32_16x16x32_bf16 v[52:55], v[84:87], v[96:99], v[52:55]
    v_mfma_f32_16x16x32_bf16 v[56:59], v[68:71], v[116:119], v[56:59]
    v_mfma_f32_16x16x32_bf16 v[56:59], v[84:87], v[100:103], v[56:59]
    v_mfma_f32_16x16x32_bf16 v[60:63], v[72:75], v[116:119], v[60:63]
    v_mfma_f32_16x16x32_bf16 v[60:63], v[84:87], v[104:107], v[60:63]
    v_mfma_f32_16x16x32_bf16 v[56:59], v[64:67], v[120:123], v[56:59]
    v_mfma_f32_16x16x32_bf16 v[56:59], v[88:91], v[96:99], v[56:59]
    v_mfma_f32_16x16x32_bf16 v[60:63], v[68:71], v[120:123], v[60:63]
    v_mfma_f32_16x16x32_bf16 v[60:63], v[88:91], v[100:103], v[60:63]
    v_mfma_f32_16x16x32_bf16 v[60:63], v[64:67], v[124:127], v[60:63]
    v_mfma_f32_16x16x32_bf16 v[60:63], v[92:95], v[96:99], v[60:63]
    s_waitcnt lgkmcnt(0)
    s_nop 0
    v_mfma_f32_16x16x32_bf16 v[32:35], v[128:131], v[160:163], v[32:35]
    ds_read_b128 v[96:99], v6 offset:0
    v_mfma_f32_16x16x32_bf16 v[36:39], v[128:131], v[164:167], v[36:39]
    ds_read_b64 v[64:65], v8 offset:3648
    v_mfma_f32_16x16x32_bf16 v[36:39], v[132:135], v[160:163], v[36:39]
    ds_read_b64 v[66:67], v8 offset:3656
    v_mfma_f32_16x16x32_bf16 v[40:43], v[132:135], v[164:167], v[40:43]
    ds_read_b128 v[100:103], v6 offset:1024
    v_mfma_f32_16x16x32_bf16 v[40:43], v[128:131], v[168:171], v[40:43]
    ds_read_b64 v[68:69], v8 offset:3136
    v_mfma_f32_16x16x32_bf16 v[40:43], v[136:139], v[160:163], v[40:43]
    ds_read_b64 v[70:71], v8 offset:3144
    v_mfma_f32_16x16x32_bf16 v[44:47], v[132:135], v[168:171], v[44:47]
    ds_read_b128 v[104:107], v6 offset:2048
    v_mfma_f32_16x16x32_bf16 v[44:47], v[136:139], v[164:167], v[44:47]
    ds_read_b64 v[72:73], v8 offset:2624
    v_mfma_f32_16x16x32_bf16 v[48:51], v[136:139], v[168:171], v[48:51]
    ds_read_b64 v[74:75], v8 offset:2632
    v_mfma_f32_16x16x32_bf16 v[44:47], v[128:131], v[172:175], v[44:47]
    ds_read_b128 v[108:111], v6 offset:3072
    v_mfma_f32_16x16x32_bf16 v[44:47], v[140:143], v[160:163], v[44:47]
    ds_read_b64 v[76:77], v8 offset:2112
    v_mfma_f32_16x16x32_bf16 v[48:51], v[132:135], v[172:175], v[48:51]
    ds_read_b64 v[78:79], v8 offset:2120
    v_mfma_f32_16x16x32_bf16 v[48:51], v[140:143], v[164:167], v[48:51]
    ds_read_b128 v[112:115], v6 offset:4096
    v_mfma_f32_16x16x32_bf16 v[52:55], v[136:139], v[172:175], v[52:55]
    ds_read_b64 v[80:81], v8 offset:1600
    v_mfma_f32_16x16x32_bf16 v[52:55], v[140:143], v[168:171], v[52:55]
    ds_read_b64 v[82:83], v8 offset:1608
    v_mfma_f32_16x16x32_bf16 v[56:59], v[140:143], v[172:175], v[56:59]
    ds_read_b128 v[116:119], v6 offset:5120
    v_mfma_f32_16x16x32_bf16 v[48:51], v[128:131], v[176:179], v[48:51]
    ds_read_b64 v[84:85], v8 offset:1088
    v_mfma_f32_16x16x32_bf16 v[48:51], v[144:147], v[160:163], v[48:51]
    ds_read_b64 v[86:87], v8 offset:1096
    v_mfma_f32_16x16x32_bf16 v[52:55], v[132:135], v[176:179], v[52:55]
    ds_read_b128 v[120:123], v6 offset:6144
    v_mfma_f32_16x16x32_bf16 v[52:55], v[144:147], v[164:167], v[52:55]
    ds_read_b64 v[88:89], v8 offset:576
    v_mfma_f32_16x16x32_bf16 v[56:59], v[136:139], v[176:179], v[56:59]
    ds_read_b64 v[90:91], v8 offset:584
    v_mfma_f32_16x16x32_bf16 v[56:59], v[144:147], v[168:171], v[56:59]
    ds_read_b128 v[124:127], v6 offset:7168
    v_mfma_f32_16x16x32_bf16 v[60:63], v[140:143], v[176:179], v[60:63]
    ds_read_b64 v[92:93], v8 offset:64
    v_mfma_f32_16x16x32_bf16 v[60:63], v[144:147], v[172:175], v[60:63]
    ds_read_b64 v[94:95], v8 offset:72
    v_mfma_f32_16x16x32_bf16 v[52:55], v[128:131], v[180:183], v[52:55]
    v_mfma_f32_16x16x32_bf16 v[52:55], v[148:151], v[160:163], v[52:55]
    v_mfma_f32_16x16x32_bf16 v[56:59], v[132:135], v[180:183], v[56:59]
    v_mfma_f32_16x16x32_bf16 v[56:59], v[148:151], v[164:167], v[56:59]
    v_mfma_f32_16x16x32_bf16 v[60:63], v[136:139], v[180:183], v[60:63]
    v_mfma_f32_16x16x32_bf16 v[60:63], v[148:151], v[168:171], v[60:63]
    v_mfma_f32_16x16x32_bf16 v[56:59], v[128:131], v[184:187], v[56:59]
    v_mfma_f32_16x16x32_bf16 v[56:59], v[152:155], v[160:163], v[56:59]
    v_mfma_f32_16x16x32_bf16 v[60:63], v[132:135], v[184:187], v[60:63]
    v_mfma_f32_16x16x32_bf16 v[60:63], v[152:155], v[164:167], v[60:63]
    v_mfma_f32_16x16x32_bf16 v[60:63], v[128:131], v[188:191], v[60:63]
    v_mfma_f32_16x16x32_bf16 v[60:63], v[156:159], v[160:163], v[60:63]
    s_waitcnt lgkmcnt(0)
    s_nop 0
    v_mfma_f32_16x16x32_bf16 v[32:35], v[64:67], v[96:99], v[32:35]
    ds_read_b128 v[160:163], v7 offset:0
    v_mfma_f32_16x16x32_bf16 v[36:39], v[64:67], v[100:103], v[36:39]
    ds_read_b64 v[128:129], v8 offset:3584
    v_mfma_f32_16x16x32_bf16 v[36:39], v[68:71], v[96:99], v[36:39]
    ds_read_b64 v[130:131], v8 offset:3592
    v_mfma_f32_16x16x32_bf16 v[40:43], v[68:71], v[100:103], v[40:43]
    ds_read_b128 v[164:167], v7 offset:1024
    v_mfma_f32_16x16x32_bf16 v[40:43], v[64:67], v[104:107], v[40:43]
    ds_read_b64 v[132:133], v8 offset:3072
    v_mfma_f32_16x16x32_bf16 v[40:43], v[72:75], v[96:99], v[40:43]
    ds_read_b64 v[134:135], v8 offset:3080
    v_mfma_f32_16x16x32_bf16 v[44:47], v[68:71], v[104:107], v[44:47]
    ds_read_b128 v[168:171], v7 offset:2048
    v_mfma_f32_16x16x32_bf16 v[44:47], v[72:75], v[100:103], v[44:47]
    ds_read_b64 v[136:137], v8 offset:2560
    v_mfma_f32_16x16x32_bf16 v[48:51], v[72:75], v[104:107], v[48:51]
    ds_read_b64 v[138:139], v8 offset:2568
    v_mfma_f32_16x16x32_bf16 v[44:47], v[64:67], v[108:111], v[44:47]
    ds_read_b128 v[172:175], v7 offset:3072
    v_mfma_f32_16x16x32_bf16 v[44:47], v[76:79], v[96:99], v[44:47]
    ds_read_b64 v[140:141], v8 offset:2048
    v_mfma_f32_16x16x32_bf16 v[48:51], v[68:71], v[108:111], v[48:51]
    ds_read_b64 v[142:143], v8 offset:2056
    v_mfma_f32_16x16x32_bf16 v[48:51], v[76:79], v[100:103], v[48:51]
    ds_read_b128 v[176:179], v7 offset:4096
    v_mfma_f32_16x16x32_bf16 v[52:55], v[72:75], v[108:111], v[52:55]
    ds_read_b64 v[144:145], v8 offset:1536
    v_mfma_f32_16x16x32_bf16 v[52:55], v[76:79], v[104:107], v[52:55]
    ds_read_b64 v[146:147], v8 offset:1544
    v_mfma_f32_16x16x32_bf16 v[56:59], v[76:79], v[108:111], v[56:59]
    ds_read_b128 v[180:183], v7 offset:5120
    v_mfma_f32_16x16x32_bf16 v[48:51], v[64:67], v[112:115], v[48:51]
    ds_read_b64 v[148:149], v8 offset:1024
    v_mfma_f32_16x16x32_bf16 v[48:51], v[80:83], v[96:99], v[48:51]
    ds_read_b64 v[150:151], v8 offset:1032
    v_mfma_f32_16x16x32_bf16 v[52:55], v[68:71], v[112:115], v[52:55]
    ds_read_b128 v[184:187], v7 offset:6144
    v_mfma_f32_16x16x32_bf16 v[52:55], v[80:83], v[100:103], v[52:55]
    ds_read_b64 v[152:153], v8 offset:512
    v_mfma_f32_16x16x32_bf16 v[56:59], v[72:75], v[112:115], v[56:59]
    ds_read_b64 v[154:155], v8 offset:520
    v_mfma_f32_16x16x32_bf16 v[56:59], v[80:83], v[104:107], v[56:59]
    ds_read_b128 v[188:191], v7 offset:7168
    v_mfma_f32_16x16x32_bf16 v[60:63], v[76:79], v[112:115], v[60:63]
    ds_read_b64 v[156:157], v8 offset:0
    v_mfma_f32_16x16x32_bf16 v[60:63], v[80:83], v[108:111], v[60:63]
    ds_read_b64 v[158:159], v8 offset:8
    v_mfma_f32_16x16x32_bf16 v[52:55], v[64:67], v[116:119], v[52:55]
    v_mfma_f32_16x16x32_bf16 v[52:55], v[84:87], v[96:99], v[52:55]
    v_mfma_f32_16x16x32_bf16 v[56:59], v[68:71], v[116:119], v[56:59]
    v_mfma_f32_16x16x32_bf16 v[56:59], v[84:87], v[100:103], v[56:59]
    v_mfma_f32_16x16x32_bf16 v[60:63], v[72:75], v[116:119], v[60:63]
    v_mfma_f32_16x16x32_bf16 v[60:63], v[84:87], v[104:107], v[60:63]
    v_mfma_f32_16x16x32_bf16 v[56:59], v[64:67], v[120:123], v[56:59]
    v_mfma_f32_16x16x32_bf16 v[56:59], v[88:91], v[96:99], v[56:59]
    v_mfma_f32_16x16x32_bf16 v[60:63], v[68:71], v[120:123], v[60:63]
    v_mfma_f32_16x16x32_bf16 v[60:63], v[88:91], v[100:103], v[60:63]
    v_mfma_f32_16x16x32_bf16 v[60:63], v[64:67], v[124:127], v[60:63]
    v_mfma_f32_16x16x32_bf16 v[60:63], v[92:95], v[96:99], v[60:63]
    s_waitcnt lgkmcnt(0)
    v_mfma_f32_16x16x32_bf16 v[32:35], v[128:131], v[160:163], v[32:35]
    s_add_u32 s38, s38, 32
    v_mov_b32 v251, s38
    s_mov_b64 exec, 1
    ds_write_b32 v251, v253
    s_mov_b64 exec, -1
    s_nop 0
    v_mfma_f32_16x16x32_bf16 v[36:39], v[128:131], v[164:167], v[36:39]
    v_mfma_f32_16x16x32_bf16 v[36:39], v[132:135], v[160:163], v[36:39]
    v_mfma_f32_16x16x32_bf16 v[40:43], v[132:135], v[164:167], v[40:43]
    s_lshl_b32 s32, s58, 12
    s_add_u32 s32, s32, s59
    v_lshl_add_u32 v16, v1, 4, s32
    v_mfma_f32_16x16x32_bf16 v[40:43], v[128:131], v[168:171], v[40:43]
    v_mfma_f32_16x16x32_bf16 v[40:43], v[136:139], v[160:163], v[40:43]
    s_lshl_b32 s32, s58, 12
    s_xor_b32 s32, s32, 4096
    s_add_u32 s32, s32, s59
    v_lshl_add_u32 v17, v1, 4, s32
    v_mfma_f32_16x16x32_bf16 v[44:47], v[132:135], v[168:171], v[44:47]
    v_mfma_f32_16x16x32_bf16 v[44:47], v[136:139], v[164:167], v[44:47]
    s_lshl_b32 s32, s54, 12
    s_lshl_b32 s33, s58, 11
    s_add_u32 s32, s32, s33
    s_nop 0
    s_add_u32 s34, s32, 10485760
    v_mfma_f32_16x16x32_bf16 v[48:51], v[136:139], v[168:171], v[48:51]
    v_mfma_f32_16x16x32_bf16 v[44:47], v[128:131], v[172:175], v[44:47]
    v_lshlrev_b32_e64 v18, 4, v1
    v_mfma_f32_16x16x32_bf16 v[44:47], v[140:143], v[160:163], v[44:47]
    v_mfma_f32_16x16x32_bf16 v[48:51], v[132:135], v[172:175], v[48:51]
    s_and_b32 s32, s54, 7
    s_cmp_eq_u32 s32, 3
    s_cselect_b32 s32, 7, s32
    s_lshl_b32 s32, s32, 7
    v_mfma_f32_16x16x32_bf16 v[48:51], v[140:143], v[164:167], v[48:51]
    v_mfma_f32_16x16x32_bf16 v[52:55], v[136:139], v[172:175], v[52:55]
    s_add_u32 s32, s32, 20971136
    v_lshrrev_b32_e64 v19, 3, v1
    v_cmp_eq_u32 s[42:43], 3, v19
    v_mfma_f32_16x16x32_bf16 v[52:55], v[140:143], v[168:171], v[52:55]
    v_mfma_f32_16x16x32_bf16 v[56:59], v[140:143], v[172:175], v[56:59]
    v_add_u32_e64 v19, s32, v18
    v_mfma_f32_16x16x32_bf16 v[48:51], v[128:131], v[176:179], v[48:51]
    v_mfma_f32_16x16x32_bf16 v[48:51], v[144:147], v[160:163], v[48:51]
    v_cndmask_b32 v18, v18, v19, s[42:43]
    v_mfma_f32_16x16x32_bf16 v[52:55], v[132:135], v[176:179], v[52:55]
    v_mfma_f32_16x16x32_bf16 v[52:55], v[144:147], v[164:167], v[52:55]
    v_mfma_f32_16x16x32_bf16 v[56:59], v[136:139], v[176:179], v[56:59]
    v_mfma_f32_16x16x32_bf16 v[56:59], v[144:147], v[168:171], v[56:59]
    v_mfma_f32_16x16x32_bf16 v[60:63], v[140:143], v[176:179], v[60:63]
    v_mfma_f32_16x16x32_bf16 v[60:63], v[144:147], v[172:175], v[60:63]
    v_mfma_f32_16x16x32_bf16 v[52:55], v[128:131], v[180:183], v[52:55]
    v_mfma_f32_16x16x32_bf16 v[52:55], v[148:151], v[160:163], v[52:55]
    s_xor_b32 s39, s38, 8
    v_mov_b32 v250, s39
    ds_read_b32 v251, v250
    v_mfma_f32_16x16x32_bf16 v[56:59], v[132:135], v[180:183], v[56:59]
    v_mfma_f32_16x16x32_bf16 v[56:59], v[148:151], v[164:167], v[56:59]
    v_mfma_f32_16x16x32_bf16 v[60:63], v[136:139], v[180:183], v[60:63]
    v_mfma_f32_16x16x32_bf16 v[60:63], v[148:151], v[168:171], v[60:63]
    v_mfma_f32_16x16x32_bf16 v[56:59], v[128:131], v[184:187], v[56:59]
    v_mfma_f32_16x16x32_bf16 v[56:59], v[152:155], v[160:163], v[56:59]
    v_mfma_f32_16x16x32_bf16 v[60:63], v[132:135], v[184:187], v[60:63]
    v_mfma_f32_16x16x32_bf16 v[60:63], v[152:155], v[164:167], v[60:63]
    v_mfma_f32_16x16x32_bf16 v[60:63], v[128:131], v[188:191], v[60:63]
    v_mfma_f32_16x16x32_bf16 v[60:63], v[156:159], v[160:163], v[60:63]
    s_waitcnt lgkmcnt(0)
    v_cmp_ne_u32 vcc, 0, v251
    s_getpc_b64 s[62:63]
    s_cbranch_vccnz L_stub
    s_add_u32 s38, s38, 32
    s_xor_b32 s39, s38, 8
    s_cmp_eq_u32 s58, 1
    s_cbranch_scc1 L_cf1
    ds_write_b128 v16, v[48:51] offset:0
    ds_write_b128 v16, v[52:55] offset:1024
    ds_write_b128 v16, v[56:59] offset:2048
    ds_write_b128 v16, v[60:63] offset:3072
    v_mov_b32 v251, s38
    s_mov_b64 exec, 1
    ds_write_b32 v251, v253
    s_mov_b64 exec, -1
    v_mov_b32 v250, s39
    ds_read_b32 v251, v250
    s_waitcnt lgkmcnt(0)
    v_cmp_ne_u32 vcc, 0, v251
    s_getpc_b64 s[62:63]
    s_cbranch_vccnz L_stub
    ds_read_b128 v[64:67], v17 offset:0
    ds_read_b128 v[68:71], v17 offset:1024
    ds_read_b128 v[72:75], v17 offset:2048
    ds_read_b128 v[76:79], v17 offset:3072
    s_waitcnt lgkmcnt(2)
    v_add_f32 v64, v64, v32
    v_add_f32 v65, v65, v33
    v_add_f32 v66, v66, v34
    v_add_f32 v67, v67, v35
    v_add_f32 v68, v68, v36
    v_add_f32 v69, v69, v37
    v_add_f32 v70, v70, v38
    v_add_f32_e64 v71, v71, v39
    v_cvt_pk_bf16_f32 v112, v64, v65
    v_cvt_pk_bf16_f32 v113, v66, v67
    v_cvt_pk_bf16_f32 v114, v68, v69
    v_cvt_pk_bf16_f32 v115, v70, v71
    s_nop 1
    v_permlane16_swap_b32 v112, v114
    v_permlane16_swap_b32 v113, v115
    buffer_store_dwordx4 v[112:115], v18, s[24:27], s34 offen offset:0 sc1
    s_waitcnt lgkmcnt(0)
    v_add_f32 v72, v72, v40
    v_add_f32 v73, v73, v41
    v_add_f32 v74, v74, v42
    v_add_f32 v75, v75, v43
    v_add_f32 v76, v76, v44
    v_add_f32 v77, v77, v45
    v_add_f32 v78, v78, v46
    v_add_f32 v79, v79, v47
    v_cvt_pk_bf16_f32 v116, v72, v73
    v_cvt_pk_bf16_f32 v117, v74, v75
    v_cvt_pk_bf16_f32 v118, v76, v77
    v_cvt_pk_bf16_f32 v119, v78, v79
    s_nop 1
    v_permlane16_swap_b32 v116, v118
    v_permlane16_swap_b32 v117, v119
    buffer_store_dwordx4 v[116:119], v18, s[24:27], s34 offen offset:1024 sc1
    s_branch L_cf2
L_cf1:
    ds_write_b128 v16, v[32:35] offset:0
    ds_write_b128 v16, v[36:39] offset:1024
    ds_write_b128 v16, v[40:43] offset:2048
    ds_write_b128 v16, v[44:47] offset:3072
    v_mov_b32 v251, s38
    s_mov_b64 exec, 1
    ds_write_b32 v251, v253
    s_mov_b64 exec, -1
    v_mov_b32 v250, s39
    ds_read_b32 v251, v250
    s_waitcnt lgkmcnt(0)
    v_cmp_ne_u32 vcc, 0, v251
    s_getpc_b64 s[62:63]
    s_cbranch_vccnz L_stub
    ds_read_b128 v[64:67], v17 offset:0
    ds_read_b128 v[68:71], v17 offset:1024
    ds_read_b128 v[72:75], v17 offset:2048
    ds_read_b128 v[76:79], v17 offset:3072
    s_waitcnt lgkmcnt(2)
    v_add_f32 v64, v64, v48
    v_add_f32 v65, v65, v49
    v_add_f32 v66, v66, v50
    v_add_f32 v67, v67, v51
    v_add_f32 v68, v68, v52
    v_add_f32 v69, v69, v53
    v_add_f32 v70, v70, v54
    v_add_f32_e64 v71, v71, v55
    v_cvt_pk_bf16_f32 v112, v64, v65
    v_cvt_pk_bf16_f32 v113, v66, v67
    v_cvt_pk_bf16_f32 v114, v68, v69
    v_cvt_pk_bf16_f32 v115, v70, v71
    s_nop 1
    v_permlane16_swap_b32 v112, v114
    v_permlane16_swap_b32 v113, v115
    buffer_store_dwordx4 v[112:115], v18, s[24:27], s34 offen offset:0 sc1
    s_waitcnt lgkmcnt(0)
    v_add_f32 v72, v72, v56
    v_add_f32 v73, v73, v57
    v_add_f32 v74, v74, v58
    v_add_f32 v75, v75, v59
    v_add_f32 v76, v76, v60
    v_add_f32 v77, v77, v61
    v_add_f32 v78, v78, v62
    v_add_f32 v79, v79, v63
    v_cvt_pk_bf16_f32 v116, v72, v73
    v_cvt_pk_bf16_f32 v117, v74, v75
    v_cvt_pk_bf16_f32 v118, v76, v77
    v_cvt_pk_bf16_f32 v119, v78, v79
    s_nop 1
    v_permlane16_swap_b32 v116, v118
    v_permlane16_swap_b32 v117, v119
    buffer_store_dwordx4 v[116:119], v18, s[24:27], s34 offen offset:1024 sc1
L_cf2:
    s_setprio 0
    s_add_u32 s38, s38, 32
    v_mov_b32_e64 v251, s38
    s_mov_b64 exec, 1
    ds_write_b32 v251, v253
    s_mov_b64 exec, -1
    s_lshr_b32 s32, s54, 6
    s_lshl_b32 s32, s32, 1
    s_add_u32 s32, s32, s58
    s_lshl_b32 s32, s32, 7
    s_and_b32 s33, s54, 63
    s_add_u32 s32, s32, s33
    s_and_b32 s33, s54, 48
    s_add_u32 s32, s32, s33
    s_lshl_b32 s32, s32, 3
    s_add_u32 s36, s32, 81920
    v_mov_b32 v250, 163008
    ds_read_b64 v[250:251], v250
    s_waitcnt lgkmcnt(0)
    v_readfirstlane_b32 s4, v250
    v_readfirstlane_b32 s5, v251
    s_nop 1
    s_lshr_b32 s32, s3, 1
    s_lshl_b32 s33, s55, 2
    s_add_u32 s32, s32, s33
    s_and_b32 s33, s3, 1
    s_lshl_b32 s34, s56, 1
    s_add_u32 s33, s33, s34
    s_lshl_b32 s33, s33, 6
    s_lshl_b32 s34, s32, 14
    s_add_u32 s33, s33, s34
    v_and_b32 v20, 15, v1
    v_lshlrev_b32 v20, 10, v20
    v_and_b32 v21, 48, v1
    v_add3_u32 v249, v20, v21, s33
    buffer_load_dwordx4 v[244:247], v249, s[8:11], 0 offen
    v_bfe_u32 v20, v1, 3, 1
    v_mul_u32_u24 v20, 8320, v20
    v_and_b32_e64 v21, 7, v1
    v_lshl_add_u32 v20, v21, 3, v20
    s_mul_i32 s32, s32, 16640
    s_add_u32 s32, s32, 1056772
    buffer_load_dword v248, v20, s[24:27], s32 offen sc1
    s_waitcnt vmcnt(2)
    s_mov_b64 s[6:7], s[4:5]
    s_atomic_swap_x2 s[6:7], s[94:95], s36
    s_lshr_b32 s32, s55, 4
    s_lshl_b32 s33, s56, 1
    s_add_u32 s32, s32, s33
    s_lshl_b32 s32, s32, 2
    s_and_b32 s40, s3, 3
    s_add_u32 s32, s32, s40
    s_lshl_b32 s32, s32, 8
    s_add_u32 s36, s32, 81920
    s_mov_b64 s[100:101], s[94:95]
    v_lshrrev_b32 v12, 3, v1
    v_lshlrev_b32 v12, 12, v12
    v_and_b32_e64 v13, 3, v1
    v_lshl_add_u32 v12, v13, 4, v12
    v_bfe_u32 v13, v1, 2, 1
    v_lshl_add_u32 v12, v13, 9, v12
    v_lshrrev_b32 v14, 3, v1
    v_cmp_eq_u32 vcc, 3, v14
    s_and_b32 s33, s55, 6
    s_cmp_eq_u32 s33, 6
    v_cndmask_b32 v14, v14, 7, vcc
    s_cselect_b32 s33, 1, 0
    v_lshlrev_b32 v14, 7, v14
    v_add_u32 v14, 20971136, v14
    v_cmp_gt_u32 vcc, s33, v13
    v_add_u32 v14, v14, v12
    s_nop 0
    v_cndmask_b32_e64 v12, v12, v14, vcc
    s_lshl_b32 s37, s56, 18
    s_lshl_b32 s33, s40, 16
    s_add_u32 s37, s37, s33
    s_lshr_b32 s33, s55, 3
    s_lshl_b32 s33, s33, 10
    s_add_u32 s37, s37, s33
    s_and_b32 s33, s55, 7
    s_lshl_b32 s33, s33, 6
    s_add_u32 s37, s37, s33
    s_add_u32 s37, s37, 10485760
    s_lshl_b32 s41, s40, 11
    s_add_u32 s41, s41, 153920
    s_waitcnt vmcnt(0)
    s_lshr_b32 s34, s3, 1
    v_and_b32 v128, 15, v1
    v_mul_u32_u24 v128, 272, v128
    v_and_b32_e64 v129, 48, v1
    v_lshl_add_u32 v128, v129, 1, v128
    s_mul_i32 s35, s34, 4352
    s_lshl_b32 s43, s57, 7
    s_add_u32 s35, s35, s43
    s_add_u32 s35, s35, 110912
    v_add_u32 v128, s35, v128
    v_lshlrev_b32 v129, 6, v129
    v_bfe_u32 v130, v1, 2, 2
    v_lshl_add_u32 v129, v130, 7, v129
    v_and_b32_e64 v130, 1, v1
    v_lshl_add_u32 v129, v130, 3, v129
    v_bfe_u32 v130, v1, 1, 1
    v_lshl_add_u32 v129, v130, 6, v129
    s_lshl_b32 s35, s57, 12
    s_lshl_b32 s43, s34, 4
    s_add_u32 s35, s35, s43
    s_add_u32 s35, s35, 153920
    v_add_u32 v129, s35, v129
    v_mul_f32 v130, 0xbfb8aa3b, v248
    v_mov_b32 v132, 1.0
    v_lshlrev_b32 v136, 16, v244
    v_and_b32 v137, 0xffff0000, v244
    v_lshlrev_b32_e64 v138, 16, v245
    v_and_b32 v139, 0xffff0000, v245
    v_lshlrev_b32_e64 v140, 16, v246
    v_and_b32 v141, 0xffff0000, v246
    v_lshlrev_b32_e64 v142, 16, v247
    v_and_b32 v143, 0xffff0000, v247
    v_and_b32 v134, 3, v1
    v_lshrrev_b32 v133, 2, v1
    v_lshlrev_b32_e64 v135, 4, v134
    v_add_lshl_u32 v134, v135, v133, 2
    v_lshl_add_u32 v135, v133, 10, v135
    v_readfirstlane_b32 s35, v249
    s_nop 1
    v_add_u32 v135, s35, v135
    v_and_b32 v250, 3, v1
    v_lshlrev_b32_e64 v250, 2, v250
    v_add_u32 v250, 162736, v250
    ds_read_b32 v251, v250
    s_waitcnt lgkmcnt(0)
    v_cmp_ne_u32 vcc, 0, v251
    s_getpc_b64 s[62:63]
    s_cbranch_vccnz L_stub
    s_load_dwordx16 s[64:79], s[100:101], s36 glc
    s_add_u32 s32, s36, 64
    s_load_dwordx16 s[80:95], s[100:101], s32 glc
    s_mov_b32 s46, 0
L_sps:
    s_waitcnt lgkmcnt(0)
    s_cmp_lg_u64 s[64:65], s[4:5]
    s_cbranch_scc1 L_srs
    s_cmp_lg_u64 s[66:67], s[4:5]
    s_cbranch_scc1 L_srs
    s_cmp_lg_u64 s[68:69], s[4:5]
    s_cbranch_scc1 L_srs
    s_cmp_lg_u64 s[70:71], s[4:5]
    s_cbranch_scc1 L_srs
    s_cmp_lg_u64 s[72:73], s[4:5]
    s_cbranch_scc1 L_srs
    s_cmp_lg_u64 s[74:75], s[4:5]
    s_cbranch_scc1 L_srs
    s_cmp_lg_u64 s[76:77], s[4:5]
    s_cbranch_scc1 L_srs
    s_cmp_lg_u64 s[78:79], s[4:5]
    s_cbranch_scc1 L_srs
    s_cmp_lg_u64 s[80:81], s[4:5]
    s_cbranch_scc1 L_srs
    s_cmp_lg_u64 s[82:83], s[4:5]
    s_cbranch_scc1 L_srs
    s_cmp_lg_u64 s[84:85], s[4:5]
    s_cbranch_scc1 L_srs
    s_cmp_lg_u64 s[86:87], s[4:5]
    s_cbranch_scc1 L_srs
    s_cmp_lg_u64 s[88:89], s[4:5]
    s_cbranch_scc1 L_srs
    s_cmp_lg_u64 s[90:91], s[4:5]
    s_cbranch_scc1 L_srs
    s_cmp_lg_u64 s[92:93], s[4:5]
    s_cbranch_scc1 L_srs
    s_cmp_lg_u64 s[94:95], s[4:5]
    s_cbranch_scc1 L_srs
L_sos:
    s_add_u32 m0, s41, 0
    s_nop 0
    s_nop 0
    buffer_load_dwordx4 v12, s[24:27], s37 offen sc1 lds
    s_add_u32 m0, s41, 1024
    s_add_u32 s37, s37, 32768
    buffer_load_dwordx4 v12, s[24:27], s37 offen sc1 lds
L_final:
    s_waitcnt vmcnt(0) lgkmcnt(0)
    s_barrier
    ds_read_b128 v[56:59], v128 offset:0
    ds_read_b128 v[64:67], v128 offset:17408
    ds_read_b128 v[60:63], v128 offset:16
    ds_read_b128 v[68:71], v128 offset:17424
    ds_read_b64_tr_b16 v[72:73], v129 offset:0
    ds_read_b64_tr_b16 v[74:75], v129 offset:512
    s_waitcnt lgkmcnt(4)
    s_nop 0
    v_pk_add_f32 v[56:57], v[56:57], v[64:65]
    v_pk_add_f32 v[58:59], v[58:59], v[66:67]
    v_pk_mul_f32 v[80:81], v[56:57], v[130:131] op_sel_hi:[1,0]
    v_pk_mul_f32 v[82:83], v[58:59], v[130:131] op_sel_hi:[1,0]
    v_exp_f32 v80, v80
    v_exp_f32 v81, v81
    v_exp_f32 v82, v82
    v_exp_f32_e64 v83, v83
    s_waitcnt lgkmcnt(2)
    v_pk_add_f32 v[60:61], v[60:61], v[68:69]
    v_pk_add_f32 v[62:63], v[62:63], v[70:71]
    v_pk_mul_f32 v[84:85], v[60:61], v[130:131] op_sel_hi:[1,0]
    v_pk_mul_f32 v[86:87], v[62:63], v[130:131] op_sel_hi:[1,0]
    v_exp_f32 v84, v84
    v_exp_f32 v85, v85
    v_exp_f32 v86, v86
    v_exp_f32_e64 v87, v87
    s_waitcnt lgkmcnt(0)
    v_pk_add_f32 v[80:81], v[80:81], v[132:133] op_sel_hi:[1,0]
    v_pk_add_f32 v[82:83], v[82:83], v[132:133] op_sel_hi:[1,0]
    v_pk_add_f32 v[84:85], v[84:85], v[132:133] op_sel_hi:[1,0]
    v_pk_add_f32 v[86:87], v[86:87], v[132:133] op_sel_hi:[1,0]
    v_rcp_f32 v80, v80
    v_rcp_f32 v81, v81
    v_rcp_f32 v82, v82
    v_rcp_f32 v83, v83
    v_rcp_f32 v84, v84
    v_rcp_f32 v85, v85
    v_rcp_f32 v86, v86
    v_rcp_f32 v87, v87
    v_lshlrev_b32_e64 v64, 16, v72
    v_and_b32 v65, 0xffff0000, v72
    v_lshlrev_b32_e64 v66, 16, v73
    v_and_b32 v67, 0xffff0000, v73
    v_lshlrev_b32_e64 v68, 16, v74
    v_and_b32 v69, 0xffff0000, v74
    v_lshlrev_b32_e64 v70, 16, v75
    v_and_b32 v71, 0xffff0000, v75
    v_pk_mul_f32 v[56:57], v[56:57], v[248:249] op_sel_hi:[1,0]
    v_pk_mul_f32 v[58:59], v[58:59], v[248:249] op_sel_hi:[1,0]
    v_pk_mul_f32 v[60:61], v[60:61], v[248:249] op_sel_hi:[1,0]
    v_pk_mul_f32 v[62:63], v[62:63], v[248:249] op_sel_hi:[1,0]
    v_pk_mul_f32 v[56:57], v[56:57], v[80:81]
    v_pk_mul_f32 v[58:59], v[58:59], v[82:83]
    v_pk_mul_f32 v[60:61], v[60:61], v[84:85]
    v_pk_mul_f32 v[62:63], v[62:63], v[86:87]
    v_pk_fma_f32 v[56:57], v[56:57], v[64:65], v[136:137]
    v_pk_fma_f32 v[58:59], v[58:59], v[66:67], v[138:139]
    v_pk_fma_f32 v[60:61], v[60:61], v[68:69], v[140:141]
    v_pk_fma_f32 v[62:63], v[62:63], v[70:71], v[142:143]
    v_cvt_pk_bf16_f32 v72, v56, v57
    ds_bpermute_b32 v76, v134, v72
    v_cvt_pk_bf16_f32 v73, v58, v59
    ds_bpermute_b32 v77, v134, v73
    v_cvt_pk_bf16_f32 v74, v60, v61
    ds_bpermute_b32 v78, v134, v74
    v_cvt_pk_bf16_f32 v75, v62, v63
    ds_bpermute_b32 v79, v134, v75
    s_waitcnt lgkmcnt(0)
    buffer_store_dwordx4 v[76:79], v135, s[28:31], 0 offen sc1
L_done:
    s_endpgm
L_stub:
    s_sleep 1
    ds_read_b32 v251, v250
    s_waitcnt lgkmcnt(0)
    v_cmp_ne_u32 vcc, 0, v251
    s_cbranch_vccnz L_stub
    s_setpc_b64 s[62:63]
    .p2align 6
L_kg:
    s_setprio 1
    s_cmp_lt_u32 s3, 2
    s_cbranch_scc1 L_kg2
    s_waitcnt lgkmcnt(0)
    s_load_dword s100, s[78:79], s35
    s_load_dword s101, s[80:81], s35
    global_load_dword v226, v3, s[66:67]
    global_load_dword v227, v3, s[68:69]
    global_load_dword v228, v3, s[70:71]
    global_load_dword v229, v3, s[72:73]
    global_load_dword v230, v3, s[74:75]
    global_load_dword v231, v3, s[76:77]
L_kg2:
    v_lshrrev_b32 v34, 5, v1
    v_and_b32 v35, 31, v1
    v_lshlrev_b32 v36, 4, v34
    v_sub_u32 v36, v35, v36
    v_cvt_f32_u32_e64 v3, v34
    v_mul_f32 v3, 0x43000000, v3
    v_and_b32 v32, 1, v36
    v_lshlrev_b32 v32, 4, v32
    v_mov_b32 v33, 0x3f80
    v_lshlrev_b32 v32, v32, v33
    v_lshrrev_b32 v33, 1, v36
    v_cmp_eq_u32_e64 vcc, 0, v33
    v_cmp_eq_u32 s[32:33], 1, v33
    s_nop 0
    v_cndmask_b32 v200, 0, v32, vcc
    v_cndmask_b32 v201, 0, v32, s[32:33]
    v_cmp_eq_u32_e64 vcc, 2, v33
    v_cmp_eq_u32 s[32:33], 3, v33
    s_nop 0
    v_cndmask_b32 v202, 0, v32, vcc
    v_cndmask_b32 v203, 0, v32, s[32:33]
    v_cmp_eq_u32_e64 vcc, 4, v33
    v_cmp_eq_u32 s[32:33], 5, v33
    s_nop 0
    v_cndmask_b32 v204, 0, v32, vcc
    v_cndmask_b32 v205, 0, v32, s[32:33]
    v_cmp_eq_u32_e64 vcc, 6, v33
    v_cmp_eq_u32 s[32:33], 7, v33
    s_nop 0
    v_cndmask_b32 v206, 0, v32, vcc
    v_cndmask_b32 v207, 0, v32, s[32:33]
    s_lshr_b32 s32, s48, 1
    s_and_b32 s33, s48, 1
    s_and_b32 s34, s49, 3
    s_lshr_b32 s35, s49, 2
    s_and_b32 s56, s49, 7
    s_lshr_b32 s55, s53, 3
    s_mul_i32 s52, s34, 0
    s_mul_i32 s51, s33, 7
    s_add_u32 s51, s51, s35
    s_lshl_b32 s36, s33, 1
    s_add_u32 s36, s36, s34
    s_cmp_ge_u32 s49, 28
    s_cselect_b32 s51, 14, s51
    s_cselect_b32 s34, s36, s34
    s_and_b32 s34, s34, 3
    s_lshl_b32 s50, s32, 2
    s_add_u32 s50, s50, s34
    s_nop 0
    s_bfe_u32 s58, s3, 0x10001
    s_mov_b32 s10, 0x200000
    s_mov_b32 s11, 0x20000
    s_barrier
    s_waitcnt vmcnt(0) lgkmcnt(0)
    s_mov_b64 s[44:45], s[100:101]
    s_load_dwordx2 s[6:7], s[94:95], 0
    s_bitcmp1_b32 s54, 0
    s_cselect_b32 s46, 0, 16
    s_lshl_b32 s44, s44, s46
    s_lshl_b32 s45, s45, s46
    s_nop 0
    s_and_b32 s44, s44, 0xffff0000
    s_and_b32 s45, s45, 0xffff0000
    v_mov_b32 v32, 0x3fb8aa3b
    v_mul_f32_e64 v33, s44, v32
    v_fma_f32 v34, s44, v32, -v33
    v_mov_b32 v35, 0x32a57060
    v_fma_f32 v34, s44, v35, v34
    v_exp_f32_e64 v33, v33
    v_mul_f32 v34, 0x3f317218, v34
    v_fma_f32 v33, v33, v34, v33
    v_cvt_pk_bf16_f32 v33, v33, v33
    v_and_b32 v2, 0xffff0000, v33
    v_lshlrev_b32_e64 v4, 16, v226
    v_and_b32 v5, 0xffff0000, v226
    v_lshlrev_b32_e64 v6, 16, v227
    v_and_b32 v7, 0xffff0000, v227
    v_mul_f32 v4, v2, v4
    v_mul_f32 v5, v2, v5
    v_mul_f32 v6, v2, v6
    v_mul_f32 v7, v2, v7
    v_mul_f32 v4, 0x3fb8aa3b, v4
    v_mul_f32_e64 v6, 0x3e22f983, v6
    v_mul_f32 v5, 0x3fb8aa3b, v5
    v_mul_f32_e64 v7, 0x3e22f983, v7
    v_mul_f32 v32, 0x41000000, v4
    v_mul_f32 v33, 0x41000000, v6
    v_mul_f32 v36, 0x41000000, v5
    v_mul_f32 v37, 0x41000000, v7
    v_mul_f32 v40, v3, v4
    v_mul_f32 v41, v3, v6
    v_mul_f32 v44, v3, v5
    v_mul_f32 v45, v3, v7
    v_mul_f32 v48, 1.0, v4
    v_mul_f32 v49, 1.0, v6
    v_mul_f32 v52, 1.0, v5
    v_mul_f32 v53, 1.0, v7
    v_mul_f32 v56, 0x44000000, v4
    v_mul_f32 v57, 0x44000000, v6
    v_mul_f32 v60, 0x44000000, v5
    v_mul_f32 v61, 0x44000000, v7
    v_rndne_f32 v34, v33
    v_exp_f32 v32, v32
    v_rndne_f32 v38, v37
    v_exp_f32 v36, v36
    v_rndne_f32 v42, v41
    v_exp_f32 v40, v40
    v_rndne_f32 v46, v45
    v_exp_f32 v44, v44
    v_rndne_f32 v50, v49
    v_exp_f32 v48, v48
    v_rndne_f32 v54, v53
    v_exp_f32 v52, v52
    v_rndne_f32 v58, v57
    v_exp_f32 v56, v56
    v_rndne_f32 v62, v61
    v_exp_f32 v60, v60
    v_sub_f32 v33, v33, v34
    v_sub_f32 v37, v37, v38
    v_sub_f32 v41, v41, v42
    v_sub_f32 v45, v45, v46
    v_sub_f32 v49, v49, v50
    v_sub_f32 v53, v53, v54
    v_sub_f32 v57, v57, v58
    v_sub_f32 v61, v61, v62
    v_cos_f32 v34, v33
    v_sin_f32 v35, v33
    v_cos_f32 v38, v37
    v_sin_f32 v39, v37
    v_cos_f32 v42, v41
    v_sin_f32 v43, v41
    v_cos_f32 v46, v45
    v_sin_f32 v47, v45
    v_cos_f32 v50, v49
    v_sin_f32 v51, v49
    v_cos_f32 v54, v53
    v_sin_f32 v55, v53
    v_cos_f32 v58, v57
    v_sin_f32 v59, v57
    v_cos_f32 v62, v61
    v_sin_f32 v63, v61
    s_nop 0
    v_mul_f32 v8, v34, v32
    v_mul_f32 v9, v35, v32
    v_mul_f32 v10, v38, v36
    v_mul_f32 v11, v39, v36
    v_mul_f32 v20, v42, v40
    v_mul_f32 v21, v43, v40
    v_mul_f32 v22, v46, v44
    v_mul_f32 v23, v47, v44
    v_mul_f32 v12, v50, v48
    v_mul_f32 v13, v51, v48
    v_mul_f32 v14, v54, v52
    v_mul_f32 v15, v55, v52
    v_mul_f32 v16, v58, v56
    v_mul_f32 v17, v59, v56
    v_mul_f32 v18, v62, v60
    v_mul_f32_e64 v19, v63, v60
    v_pk_mul_f32 v[24:25], v[8:9], v[8:9] op_sel:[0,0] op_sel_hi:[0,1]
    v_pk_mul_f32 v[26:27], v[10:11], v[10:11] op_sel:[0,0] op_sel_hi:[0,1]
    v_pk_mul_f32 v[36:37], v[20:21], v[8:9] op_sel:[0,0] op_sel_hi:[0,1]
    v_pk_mul_f32 v[38:39], v[22:23], v[10:11] op_sel:[0,0] op_sel_hi:[0,1]
    v_pk_mul_f32 v[28:29], v[12:13], v[12:13] op_sel:[0,0] op_sel_hi:[0,1]
    v_pk_mul_f32 v[30:31], v[14:15], v[14:15] op_sel:[0,0] op_sel_hi:[0,1]
    v_pk_fma_f32 v[24:25], v[8:9], v[8:9], v[24:25] op_sel:[1,1,0] op_sel_hi:[1,0,1] neg_lo:[0,1,0]
    v_pk_fma_f32 v[26:27], v[10:11], v[10:11], v[26:27] op_sel:[1,1,0] op_sel_hi:[1,0,1] neg_lo:[0,1,0]
    v_pk_fma_f32 v[36:37], v[20:21], v[8:9], v[36:37] op_sel:[1,1,0] op_sel_hi:[1,0,1] neg_lo:[0,1,0]
    v_pk_fma_f32 v[38:39], v[22:23], v[10:11], v[38:39] op_sel:[1,1,0] op_sel_hi:[1,0,1] neg_lo:[0,1,0]
    v_pk_fma_f32 v[28:29], v[12:13], v[12:13], v[28:29] op_sel:[1,1,0] op_sel_hi:[1,0,1] neg_lo:[0,1,0]
    v_pk_fma_f32 v[30:31], v[14:15], v[14:15], v[30:31] op_sel:[1,1,0] op_sel_hi:[1,0,1] neg_lo:[0,1,0]
    v_pk_mul_f32 v[40:41], v[20:21], v[24:25] op_sel:[0,0] op_sel_hi:[0,1]
    v_pk_mul_f32 v[42:43], v[22:23], v[26:27] op_sel:[0,0] op_sel_hi:[0,1]
    v_pk_mul_f32 v[44:45], v[36:37], v[24:25] op_sel:[0,0] op_sel_hi:[0,1]
    v_pk_mul_f32 v[46:47], v[38:39], v[26:27] op_sel:[0,0] op_sel_hi:[0,1]
    v_pk_fma_f32 v[40:41], v[20:21], v[24:25], v[40:41] op_sel:[1,1,0] op_sel_hi:[1,0,1] neg_lo:[0,1,0]
    v_pk_fma_f32 v[42:43], v[22:23], v[26:27], v[42:43] op_sel:[1,1,0] op_sel_hi:[1,0,1] neg_lo:[0,1,0]
    v_pk_fma_f32 v[44:45], v[36:37], v[24:25], v[44:45] op_sel:[1,1,0] op_sel_hi:[1,0,1] neg_lo:[0,1,0]
    v_pk_fma_f32 v[46:47], v[38:39], v[26:27], v[46:47] op_sel:[1,1,0] op_sel_hi:[1,0,1] neg_lo:[0,1,0]
    v_cvt_pk_bf16_f32 v128, v20, v36
    v_cvt_pk_bf16_f32 v136, v21, v37
    v_cvt_pk_bf16_f32 v144, v22, v38
    v_cvt_pk_bf16_f32 v152, v23, v39
    v_pk_mul_f32 v[32:33], v[40:41], v[24:25] op_sel:[0,0] op_sel_hi:[0,1]
    v_pk_mul_f32 v[34:35], v[42:43], v[26:27] op_sel:[0,0] op_sel_hi:[0,1]
    v_pk_mul_f32 v[36:37], v[44:45], v[24:25] op_sel:[0,0] op_sel_hi:[0,1]
    v_pk_mul_f32 v[38:39], v[46:47], v[26:27] op_sel:[0,0] op_sel_hi:[0,1]
    v_pk_fma_f32 v[32:33], v[40:41], v[24:25], v[32:33] op_sel:[1,1,0] op_sel_hi:[1,0,1] neg_lo:[0,1,0]
    v_pk_fma_f32 v[34:35], v[42:43], v[26:27], v[34:35] op_sel:[1,1,0] op_sel_hi:[1,0,1] neg_lo:[0,1,0]
    v_pk_fma_f32 v[36:37], v[44:45], v[24:25], v[36:37] op_sel:[1,1,0] op_sel_hi:[1,0,1] neg_lo:[0,1,0]
    v_pk_fma_f32 v[38:39], v[46:47], v[26:27], v[38:39] op_sel:[1,1,0] op_sel_hi:[1,0,1] neg_lo:[0,1,0]
    v_cvt_pk_bf16_f32 v129, v40, v44
    v_cvt_pk_bf16_f32 v137, v41, v45
    v_cvt_pk_bf16_f32 v145, v42, v46
    v_cvt_pk_bf16_f32 v153, v43, v47
    v_pk_mul_f32 v[40:41], v[32:33], v[24:25] op_sel:[0,0] op_sel_hi:[0,1]
    v_pk_mul_f32 v[42:43], v[34:35], v[26:27] op_sel:[0,0] op_sel_hi:[0,1]
    v_pk_mul_f32 v[44:45], v[36:37], v[24:25] op_sel:[0,0] op_sel_hi:[0,1]
    v_pk_mul_f32 v[46:47], v[38:39], v[26:27] op_sel:[0,0] op_sel_hi:[0,1]
    v_pk_fma_f32 v[40:41], v[32:33], v[24:25], v[40:41] op_sel:[1,1,0] op_sel_hi:[1,0,1] neg_lo:[0,1,0]
    v_pk_fma_f32 v[42:43], v[34:35], v[26:27], v[42:43] op_sel:[1,1,0] op_sel_hi:[1,0,1] neg_lo:[0,1,0]
    v_pk_fma_f32 v[44:45], v[36:37], v[24:25], v[44:45] op_sel:[1,1,0] op_sel_hi:[1,0,1] neg_lo:[0,1,0]
    v_pk_fma_f32 v[46:47], v[38:39], v[26:27], v[46:47] op_sel:[1,1,0] op_sel_hi:[1,0,1] neg_lo:[0,1,0]
    v_cvt_pk_bf16_f32 v130, v32, v36
    v_cvt_pk_bf16_f32 v138, v33, v37
    v_cvt_pk_bf16_f32 v146, v34, v38
    v_cvt_pk_bf16_f32 v154, v35, v39
    v_pk_mul_f32 v[32:33], v[40:41], v[24:25] op_sel:[0,0] op_sel_hi:[0,1]
    v_pk_mul_f32 v[34:35], v[42:43], v[26:27] op_sel:[0,0] op_sel_hi:[0,1]
    v_pk_mul_f32 v[36:37], v[44:45], v[24:25] op_sel:[0,0] op_sel_hi:[0,1]
    v_pk_mul_f32 v[38:39], v[46:47], v[26:27] op_sel:[0,0] op_sel_hi:[0,1]
    v_pk_fma_f32 v[32:33], v[40:41], v[24:25], v[32:33] op_sel:[1,1,0] op_sel_hi:[1,0,1] neg_lo:[0,1,0]
    v_pk_fma_f32 v[34:35], v[42:43], v[26:27], v[34:35] op_sel:[1,1,0] op_sel_hi:[1,0,1] neg_lo:[0,1,0]
    v_pk_fma_f32 v[36:37], v[44:45], v[24:25], v[36:37] op_sel:[1,1,0] op_sel_hi:[1,0,1] neg_lo:[0,1,0]
    v_pk_fma_f32 v[38:39], v[46:47], v[26:27], v[38:39] op_sel:[1,1,0] op_sel_hi:[1,0,1] neg_lo:[0,1,0]
    v_cvt_pk_bf16_f32 v131, v40, v44
    v_cvt_pk_bf16_f32 v139, v41, v45
    v_cvt_pk_bf16_f32 v147, v42, v46
    v_cvt_pk_bf16_f32 v155, v43, v47
    v_pk_mul_f32 v[40:41], v[32:33], v[24:25] op_sel:[0,0] op_sel_hi:[0,1]
    v_pk_mul_f32 v[42:43], v[34:35], v[26:27] op_sel:[0,0] op_sel_hi:[0,1]
    v_pk_mul_f32 v[44:45], v[36:37], v[24:25] op_sel:[0,0] op_sel_hi:[0,1]
    v_pk_mul_f32 v[46:47], v[38:39], v[26:27] op_sel:[0,0] op_sel_hi:[0,1]
    v_pk_fma_f32 v[40:41], v[32:33], v[24:25], v[40:41] op_sel:[1,1,0] op_sel_hi:[1,0,1] neg_lo:[0,1,0]
    v_pk_fma_f32 v[42:43], v[34:35], v[26:27], v[42:43] op_sel:[1,1,0] op_sel_hi:[1,0,1] neg_lo:[0,1,0]
    v_pk_fma_f32 v[44:45], v[36:37], v[24:25], v[44:45] op_sel:[1,1,0] op_sel_hi:[1,0,1] neg_lo:[0,1,0]
    v_pk_fma_f32 v[46:47], v[38:39], v[26:27], v[46:47] op_sel:[1,1,0] op_sel_hi:[1,0,1] neg_lo:[0,1,0]
    v_cvt_pk_bf16_f32 v132, v32, v36
    v_cvt_pk_bf16_f32 v140, v33, v37
    v_cvt_pk_bf16_f32 v148, v34, v38
    v_cvt_pk_bf16_f32 v156, v35, v39
    v_pk_mul_f32 v[32:33], v[40:41], v[24:25] op_sel:[0,0] op_sel_hi:[0,1]
    v_pk_mul_f32 v[34:35], v[42:43], v[26:27] op_sel:[0,0] op_sel_hi:[0,1]
    v_pk_mul_f32 v[36:37], v[44:45], v[24:25] op_sel:[0,0] op_sel_hi:[0,1]
    v_pk_mul_f32 v[38:39], v[46:47], v[26:27] op_sel:[0,0] op_sel_hi:[0,1]
    v_pk_fma_f32 v[32:33], v[40:41], v[24:25], v[32:33] op_sel:[1,1,0] op_sel_hi:[1,0,1] neg_lo:[0,1,0]
    v_pk_fma_f32 v[34:35], v[42:43], v[26:27], v[34:35] op_sel:[1,1,0] op_sel_hi:[1,0,1] neg_lo:[0,1,0]
    v_pk_fma_f32 v[36:37], v[44:45], v[24:25], v[36:37] op_sel:[1,1,0] op_sel_hi:[1,0,1] neg_lo:[0,1,0]
    v_pk_fma_f32 v[38:39], v[46:47], v[26:27], v[38:39] op_sel:[1,1,0] op_sel_hi:[1,0,1] neg_lo:[0,1,0]
    v_cvt_pk_bf16_f32 v133, v40, v44
    v_cvt_pk_bf16_f32 v141, v41, v45
    v_cvt_pk_bf16_f32 v149, v42, v46
    v_cvt_pk_bf16_f32 v157, v43, v47
    v_pk_mul_f32 v[40:41], v[32:33], v[24:25] op_sel:[0,0] op_sel_hi:[0,1]
    v_pk_mul_f32 v[42:43], v[34:35], v[26:27] op_sel:[0,0] op_sel_hi:[0,1]
    v_pk_mul_f32 v[44:45], v[36:37], v[24:25] op_sel:[0,0] op_sel_hi:[0,1]
    v_pk_mul_f32 v[46:47], v[38:39], v[26:27] op_sel:[0,0] op_sel_hi:[0,1]
    v_pk_fma_f32 v[40:41], v[32:33], v[24:25], v[40:41] op_sel:[1,1,0] op_sel_hi:[1,0,1] neg_lo:[0,1,0]
    v_pk_fma_f32 v[42:43], v[34:35], v[26:27], v[42:43] op_sel:[1,1,0] op_sel_hi:[1,0,1] neg_lo:[0,1,0]
    v_pk_fma_f32 v[44:45], v[36:37], v[24:25], v[44:45] op_sel:[1,1,0] op_sel_hi:[1,0,1] neg_lo:[0,1,0]
    v_pk_fma_f32 v[46:47], v[38:39], v[26:27], v[46:47] op_sel:[1,1,0] op_sel_hi:[1,0,1] neg_lo:[0,1,0]
    v_cvt_pk_bf16_f32 v134, v32, v36
    v_cvt_pk_bf16_f32 v142, v33, v37
    v_cvt_pk_bf16_f32 v150, v34, v38
    v_cvt_pk_bf16_f32 v158, v35, v39
    v_cvt_pk_bf16_f32 v135, v40, v44
    v_cvt_pk_bf16_f32 v143, v41, v45
    v_cvt_pk_bf16_f32 v151, v42, v46
    v_cvt_pk_bf16_f32 v159, v43, v47
    s_nop 1
    v_mfma_f32_32x32x16_bf16 v[64:79], v[128:131], v[200:203], 0
    v_lshrrev_b32 v34, 5, v1
    v_and_b32_e64 v35, 31, v1
    v_mov_b32 v36, 0x76543210
    v_mov_b32 v37, 0xf6444200
    v_cmp_gt_u32_e64 vcc, 32, v1
    v_cmp_gt_u32 s[32:33], 16, v35
    v_mfma_f32_32x32x16_bf16 v[80:95], v[136:139], v[200:203], 0
    v_mov_b32 v32, 0xdcba9e8
    v_cndmask_b32_e64 v36, v37, v36, vcc
    v_cndmask_b32 v36, v32, v36, s[32:33]
    v_bfe_u32 v32, v1, 3, 1
    v_and_b32_e64 v33, 3, v1
    v_lshl_add_u32 v32, v32, 2, v33
    v_mfma_f32_32x32x16_bf16 v[96:111], v[144:147], v[200:203], 0
    v_lshlrev_b32_e64 v32, 2, v32
    v_bfe_u32 v36, v36, v32, 4
    v_bfe_u32 v32, v1, 2, 1
    v_xor_b32_e64 v32, v32, v34
    v_lshl_add_u32 v36, v32, 4, v36
    v_and_b32_e64 v32, 1, v36
    v_mfma_f32_32x32x16_bf16 v[112:127], v[152:155], v[200:203], 0
    v_lshlrev_b32_e64 v32, 4, v32
    v_mov_b32 v33, 0x3f80
    v_lshlrev_b32 v32, v32, v33
    v_lshrrev_b32 v33, 1, v36
    v_cmp_eq_u32_e64 vcc, 0, v33
    v_cmp_eq_u32 s[32:33], 1, v33
    v_mfma_f32_32x32x16_bf16 v[64:79], v[132:135], v[204:207], v[64:79]
    s_nop 0
    v_cndmask_b32 v192, 0, v32, vcc
    v_cndmask_b32 v193, 0, v32, s[32:33]
    v_cmp_eq_u32_e64 vcc, 2, v33
    v_cmp_eq_u32 s[32:33], 3, v33
    s_nop 0
    v_mfma_f32_32x32x16_bf16 v[80:95], v[140:143], v[204:207], v[80:95]
    v_cndmask_b32 v194, 0, v32, vcc
    v_cndmask_b32 v195, 0, v32, s[32:33]
    v_cmp_eq_u32_e64 vcc, 4, v33
    v_cmp_eq_u32 s[32:33], 5, v33
    s_nop 0
    v_cndmask_b32 v196, 0, v32, vcc
    v_mfma_f32_32x32x16_bf16 v[96:111], v[148:151], v[204:207], v[96:111]
    v_cndmask_b32 v197, 0, v32, s[32:33]
    v_cmp_eq_u32_e64 vcc, 6, v33
    v_cmp_eq_u32 s[32:33], 7, v33
    s_nop 0
    v_cndmask_b32 v198, 0, v32, vcc
    v_cndmask_b32 v199, 0, v32, s[32:33]
    v_mfma_f32_32x32x16_bf16 v[112:127], v[156:159], v[204:207], v[112:127]
    v_lshlrev_b32 v56, 16, v228
    v_lshlrev_b32 v60, 16, v230
    v_lshlrev_b32 v57, 16, v229
    v_lshlrev_b32 v61, 16, v231
    v_and_b32 v58, 0xffff0000, v228
    v_and_b32 v62, 0xffff0000, v230
    v_and_b32 v59, 0xffff0000, v229
    v_and_b32 v63, 0xffff0000, v231
    v_mul_f32 v56, v2, v56
    v_mul_f32 v57, v2, v57
    v_mul_f32 v58, v2, v58
    v_mul_f32 v59, v2, v59
    v_pk_mul_f32 v[36:37], v[60:61], v[56:57] op_sel:[0,0] op_sel_hi:[0,1]
    v_pk_mul_f32 v[38:39], v[62:63], v[58:59] op_sel:[0,0] op_sel_hi:[0,1]
    v_pk_mul_f32 v[40:41], v[20:21], v[20:21] op_sel:[0,0] op_sel_hi:[0,1]
    v_pk_mul_f32 v[42:43], v[22:23], v[22:23] op_sel:[0,0] op_sel_hi:[0,1]
    v_pk_fma_f32 v[36:37], v[60:61], v[56:57], v[36:37] op_sel:[1,1,0] op_sel_hi:[1,0,1] neg_lo:[0,1,0]
    v_pk_fma_f32 v[38:39], v[62:63], v[58:59], v[38:39] op_sel:[1,1,0] op_sel_hi:[1,0,1] neg_lo:[0,1,0]
    v_pk_fma_f32 v[40:41], v[20:21], v[20:21], v[40:41] op_sel:[1,1,0] op_sel_hi:[1,0,1] neg_lo:[0,1,0]
    v_pk_fma_f32 v[42:43], v[22:23], v[22:23], v[42:43] op_sel:[1,1,0] op_sel_hi:[1,0,1] neg_lo:[0,1,0]
    v_pk_mul_f32 v[32:33], v[36:37], v[40:41] op_sel:[0,0] op_sel_hi:[0,1]
    v_pk_mul_f32 v[34:35], v[38:39], v[42:43] op_sel:[0,0] op_sel_hi:[0,1]
    v_pk_fma_f32 v[32:33], v[36:37], v[40:41], v[32:33] op_sel:[1,1,0] op_sel_hi:[1,0,1] neg_lo:[0,1,0]
    v_pk_fma_f32 v[34:35], v[38:39], v[42:43], v[34:35] op_sel:[1,1,0] op_sel_hi:[1,0,1] neg_lo:[0,1,0]
    v_pk_mul_f32 v[36:37], v[32:33], v[12:13] op_sel:[0,0] op_sel_hi:[0,1]
    v_pk_mul_f32 v[38:39], v[34:35], v[14:15] op_sel:[0,0] op_sel_hi:[0,1]
    v_pk_mul_f32 v[40:41], v[32:33], v[28:29] op_sel:[0,0] op_sel_hi:[0,1]
    v_pk_mul_f32 v[42:43], v[34:35], v[30:31] op_sel:[0,0] op_sel_hi:[0,1]
    v_pk_mul_f32 v[52:53], v[32:33], v[8:9] op_sel:[0,0] op_sel_hi:[0,1]
    v_pk_mul_f32 v[54:55], v[34:35], v[10:11] op_sel:[0,0] op_sel_hi:[0,1]
    v_pk_mul_f32 v[56:57], v[32:33], v[16:17] op_sel:[0,0] op_sel_hi:[0,1]
    v_pk_mul_f32 v[58:59], v[34:35], v[18:19] op_sel:[0,0] op_sel_hi:[0,1]
    v_pk_fma_f32 v[36:37], v[32:33], v[12:13], v[36:37] op_sel:[1,1,0] op_sel_hi:[1,0,1] neg_lo:[0,1,0]
    v_pk_fma_f32 v[38:39], v[34:35], v[14:15], v[38:39] op_sel:[1,1,0] op_sel_hi:[1,0,1] neg_lo:[0,1,0]
    v_pk_fma_f32 v[40:41], v[32:33], v[28:29], v[40:41] op_sel:[1,1,0] op_sel_hi:[1,0,1] neg_lo:[0,1,0]
    v_pk_fma_f32 v[42:43], v[34:35], v[30:31], v[42:43] op_sel:[1,1,0] op_sel_hi:[1,0,1] neg_lo:[0,1,0]
    v_pk_fma_f32 v[52:53], v[32:33], v[8:9], v[52:53] op_sel:[1,1,0] op_sel_hi:[1,0,1] neg_lo:[0,1,0]
    v_pk_fma_f32 v[54:55], v[34:35], v[10:11], v[54:55] op_sel:[1,1,0] op_sel_hi:[1,0,1] neg_lo:[0,1,0]
    v_pk_fma_f32 v[56:57], v[32:33], v[16:17], v[56:57] op_sel:[1,1,0] op_sel_hi:[1,0,1] neg_lo:[0,1,0]
    v_pk_fma_f32 v[58:59], v[34:35], v[18:19], v[58:59] op_sel:[1,1,0] op_sel_hi:[1,0,1] neg_lo:[0,1,0]
    v_pk_mul_f32 v[44:45], v[36:37], v[28:29] op_sel:[0,0] op_sel_hi:[0,1]
    v_pk_mul_f32 v[46:47], v[38:39], v[30:31] op_sel:[0,0] op_sel_hi:[0,1]
    v_pk_mul_f32 v[48:49], v[40:41], v[28:29] op_sel:[0,0] op_sel_hi:[0,1]
    v_pk_mul_f32 v[50:51], v[42:43], v[30:31] op_sel:[0,0] op_sel_hi:[0,1]
    v_pk_mul_f32 v[60:61], v[52:53], v[16:17] op_sel:[0,0] op_sel_hi:[0,1]
    v_pk_mul_f32 v[62:63], v[54:55], v[18:19] op_sel:[0,0] op_sel_hi:[0,1]
    v_pk_fma_f32 v[44:45], v[36:37], v[28:29], v[44:45] op_sel:[1,1,0] op_sel_hi:[1,0,1] neg_lo:[0,1,0]
    v_pk_fma_f32 v[46:47], v[38:39], v[30:31], v[46:47] op_sel:[1,1,0] op_sel_hi:[1,0,1] neg_lo:[0,1,0]
    v_pk_fma_f32 v[48:49], v[40:41], v[28:29], v[48:49] op_sel:[1,1,0] op_sel_hi:[1,0,1] neg_lo:[0,1,0]
    v_pk_fma_f32 v[50:51], v[42:43], v[30:31], v[50:51] op_sel:[1,1,0] op_sel_hi:[1,0,1] neg_lo:[0,1,0]
    v_pk_fma_f32 v[60:61], v[52:53], v[16:17], v[60:61] op_sel:[1,1,0] op_sel_hi:[1,0,1] neg_lo:[0,1,0]
    v_pk_fma_f32 v[62:63], v[54:55], v[18:19], v[62:63] op_sel:[1,1,0] op_sel_hi:[1,0,1] neg_lo:[0,1,0]
    v_cvt_pk_bf16_f32 v128, v32, v36
    v_cvt_pk_bf16_f32 v136, -v33, -v37
    v_cvt_pk_bf16_f32 v144, v34, v38
    v_cvt_pk_bf16_f32 v152, -v35, -v39
    v_pk_mul_f32 v[36:37], v[44:45], v[28:29] op_sel:[0,0] op_sel_hi:[0,1]
    v_pk_mul_f32 v[38:39], v[46:47], v[30:31] op_sel:[0,0] op_sel_hi:[0,1]
    v_pk_mul_f32 v[32:33], v[56:57], v[16:17] op_sel:[0,0] op_sel_hi:[0,1]
    v_pk_mul_f32 v[34:35], v[58:59], v[18:19] op_sel:[0,0] op_sel_hi:[0,1]
    v_pk_fma_f32 v[36:37], v[44:45], v[28:29], v[36:37] op_sel:[1,1,0] op_sel_hi:[1,0,1] neg_lo:[0,1,0]
    v_pk_fma_f32 v[38:39], v[46:47], v[30:31], v[38:39] op_sel:[1,1,0] op_sel_hi:[1,0,1] neg_lo:[0,1,0]
    v_pk_fma_f32 v[32:33], v[56:57], v[16:17], v[32:33] op_sel:[1,1,0] op_sel_hi:[1,0,1] neg_lo:[0,1,0]
    v_pk_fma_f32 v[34:35], v[58:59], v[18:19], v[34:35] op_sel:[1,1,0] op_sel_hi:[1,0,1] neg_lo:[0,1,0]
    v_cvt_pk_bf16_f32 v129, v40, v44
    v_cvt_pk_bf16_f32 v137, -v41, -v45
    v_cvt_pk_bf16_f32 v145, v42, v46
    v_cvt_pk_bf16_f32 v153, -v43, -v47
    v_cvt_pk_bf16_f32 v132, v56, v60
    v_cvt_pk_bf16_f32 v140, -v57, -v61
    v_cvt_pk_bf16_f32 v148, v58, v62
    v_cvt_pk_bf16_f32 v156, -v59, -v63
    v_pk_mul_f32 v[40:41], v[48:49], v[28:29] op_sel:[0,0] op_sel_hi:[0,1]
    v_pk_mul_f32 v[42:43], v[50:51], v[30:31] op_sel:[0,0] op_sel_hi:[0,1]
    v_pk_mul_f32 v[44:45], v[36:37], v[28:29] op_sel:[0,0] op_sel_hi:[0,1]
    v_pk_mul_f32 v[46:47], v[38:39], v[30:31] op_sel:[0,0] op_sel_hi:[0,1]
    v_pk_mul_f32 v[56:57], v[60:61], v[16:17] op_sel:[0,0] op_sel_hi:[0,1]
    v_pk_mul_f32 v[58:59], v[62:63], v[18:19] op_sel:[0,0] op_sel_hi:[0,1]
    v_pk_fma_f32 v[40:41], v[48:49], v[28:29], v[40:41] op_sel:[1,1,0] op_sel_hi:[1,0,1] neg_lo:[0,1,0]
    v_pk_fma_f32 v[42:43], v[50:51], v[30:31], v[42:43] op_sel:[1,1,0] op_sel_hi:[1,0,1] neg_lo:[0,1,0]
    v_pk_fma_f32 v[44:45], v[36:37], v[28:29], v[44:45] op_sel:[1,1,0] op_sel_hi:[1,0,1] neg_lo:[0,1,0]
    v_pk_fma_f32 v[46:47], v[38:39], v[30:31], v[46:47] op_sel:[1,1,0] op_sel_hi:[1,0,1] neg_lo:[0,1,0]
    v_pk_fma_f32 v[56:57], v[60:61], v[16:17], v[56:57] op_sel:[1,1,0] op_sel_hi:[1,0,1] neg_lo:[0,1,0]
    v_pk_fma_f32 v[58:59], v[62:63], v[18:19], v[58:59] op_sel:[1,1,0] op_sel_hi:[1,0,1] neg_lo:[0,1,0]
    v_cvt_pk_bf16_f32 v130, v48, v36
    v_cvt_pk_bf16_f32 v138, -v49, -v37
    v_cvt_pk_bf16_f32 v146, v50, v38
    v_cvt_pk_bf16_f32 v154, -v51, -v39
    v_pk_mul_f32 v[36:37], v[48:49], v[16:17] op_sel:[0,0] op_sel_hi:[0,1]
    v_pk_mul_f32 v[38:39], v[50:51], v[18:19] op_sel:[0,0] op_sel_hi:[0,1]
    v_pk_mul_f32 v[60:61], v[32:33], v[16:17] op_sel:[0,0] op_sel_hi:[0,1]
    v_pk_mul_f32 v[62:63], v[34:35], v[18:19] op_sel:[0,0] op_sel_hi:[0,1]
    v_pk_fma_f32 v[36:37], v[48:49], v[16:17], v[36:37] op_sel:[1,1,0] op_sel_hi:[1,0,1] neg_lo:[0,1,0]
    v_pk_fma_f32 v[38:39], v[50:51], v[18:19], v[38:39] op_sel:[1,1,0] op_sel_hi:[1,0,1] neg_lo:[0,1,0]
    v_pk_fma_f32 v[60:61], v[32:33], v[16:17], v[60:61] op_sel:[1,1,0] op_sel_hi:[1,0,1] neg_lo:[0,1,0]
    v_pk_fma_f32 v[62:63], v[34:35], v[18:19], v[62:63] op_sel:[1,1,0] op_sel_hi:[1,0,1] neg_lo:[0,1,0]
    v_cvt_pk_bf16_f32 v131, v40, v44
    v_cvt_pk_bf16_f32 v139, -v41, -v45
    v_cvt_pk_bf16_f32 v147, v42, v46
    v_cvt_pk_bf16_f32 v155, -v43, -v47
    v_cvt_pk_bf16_f32 v133, v32, v56
    v_cvt_pk_bf16_f32 v141, -v33, -v57
    v_cvt_pk_bf16_f32 v149, v34, v58
    v_cvt_pk_bf16_f32 v157, -v35, -v59
    v_pk_mul_f32 v[40:41], v[56:57], v[16:17] op_sel:[0,0] op_sel_hi:[0,1]
    v_pk_mul_f32 v[42:43], v[58:59], v[18:19] op_sel:[0,0] op_sel_hi:[0,1]
    v_pk_fma_f32 v[40:41], v[56:57], v[16:17], v[40:41] op_sel:[1,1,0] op_sel_hi:[1,0,1] neg_lo:[0,1,0]
    v_pk_fma_f32 v[42:43], v[58:59], v[18:19], v[42:43] op_sel:[1,1,0] op_sel_hi:[1,0,1] neg_lo:[0,1,0]
    v_cvt_pk_bf16_f32 v135, v36, v52
    v_cvt_pk_bf16_f32 v143, -v37, -v53
    v_cvt_pk_bf16_f32 v151, v38, v54
    v_cvt_pk_bf16_f32 v159, -v39, -v55
    v_cvt_pk_bf16_f32 v134, v60, v40
    v_cvt_pk_bf16_f32 v142, -v61, -v41
    v_cvt_pk_bf16_f32 v150, v62, v42
    v_cvt_pk_bf16_f32 v158, -v63, -v43
    v_cvt_pk_bf16_f32 v160, v64, v65
    v_cvt_pk_bf16_f32 v161, v66, v67
    v_cvt_pk_bf16_f32 v162, v68, v69
    v_cvt_pk_bf16_f32 v163, v70, v71
    v_cvt_pk_bf16_f32 v164, v72, v73
    v_cvt_pk_bf16_f32 v165, v74, v75
    v_cvt_pk_bf16_f32 v166, v76, v77
    v_cvt_pk_bf16_f32 v167, v78, v79
    v_mfma_f32_32x32x16_bf16 v[64:79], v[128:131], v[192:195], 0
    s_mov_b64 s[8:9], s[64:65]
    s_mul_i32 s59, s57, 16896
    s_add_u32 s59, s59, 110912
    s_lshl_b32 s60, s57, 4
    s_add_u32 s60, s60, 144704
    s_mov_b64 s[20:21], s[88:89]
    s_nop 0
    v_mfma_f32_32x32x16_bf16 v[64:79], v[132:135], v[196:199], v[64:79]
    v_cvt_pk_bf16_f32 v168, v80, v81
    v_cvt_pk_bf16_f32 v169, v82, v83
    v_cvt_pk_bf16_f32 v170, v84, v85
    v_cvt_pk_bf16_f32 v171, v86, v87
    v_cvt_pk_bf16_f32 v172, v88, v89
    v_cvt_pk_bf16_f32 v173, v90, v91
    v_cvt_pk_bf16_f32 v174, v92, v93
    v_cvt_pk_bf16_f32 v175, v94, v95
    v_mfma_f32_32x32x16_bf16 v[80:95], v[136:139], v[192:195], 0
    s_mov_b32 s22, 1409024
    s_mov_b32 s23, 0x20000
    s_mov_b64 s[24:25], s[94:95]
    s_mov_b32 s26, 268435456
    s_mov_b32 s27, 0x20000
    s_mov_b64 s[28:29], s[90:91]
    v_mfma_f32_32x32x16_bf16 v[80:95], v[140:143], v[196:199], v[80:95]
    v_cvt_pk_bf16_f32 v176, v96, v97
    v_cvt_pk_bf16_f32 v177, v98, v99
    v_cvt_pk_bf16_f32 v178, v100, v101
    v_cvt_pk_bf16_f32 v179, v102, v103
    v_cvt_pk_bf16_f32 v180, v104, v105
    v_cvt_pk_bf16_f32 v181, v106, v107
    v_cvt_pk_bf16_f32 v182, v108, v109
    v_cvt_pk_bf16_f32 v183, v110, v111
    v_mfma_f32_32x32x16_bf16 v[96:111], v[144:147], v[192:195], 0
    s_mov_b32 s30, 2097152
    s_mov_b32 s31, 0x20000
    v_mov_b32 v252, 0x7ff00000
    v_mov_b32 v253, 0
    v_lshrrev_b32 v9, 4, v1
    v_bfe_u32 v10, v1, 2, 2
    v_mfma_f32_32x32x16_bf16 v[96:111], v[148:151], v[196:199], v[96:111]
    v_cvt_pk_bf16_f32 v184, v112, v113
    v_cvt_pk_bf16_f32 v185, v114, v115
    v_cvt_pk_bf16_f32 v186, v116, v117
    v_cvt_pk_bf16_f32 v187, v118, v119
    v_cvt_pk_bf16_f32 v188, v120, v121
    v_cvt_pk_bf16_f32 v189, v122, v123
    v_cvt_pk_bf16_f32 v190, v124, v125
    v_cvt_pk_bf16_f32 v191, v126, v127
    v_mfma_f32_32x32x16_bf16 v[112:127], v[152:155], v[192:195], 0
    v_lshl_add_u32 v10, v9, 3, v10
    v_mul_u32_u24 v10, 192, v10
    v_and_b32_e64 v11, 3, v1
    v_lshl_add_u32 v10, v11, 3, v10
    v_and_b32 v11, 1, v9
    s_mul_i32 s32, s57, 3
    v_mfma_f32_32x32x16_bf16 v[112:127], v[156:159], v[196:199], v[112:127]
    v_cvt_pk_bf16_f32 v32, v64, v65
    v_cvt_pk_bf16_f32 v33, v66, v67
    v_cvt_pk_bf16_f32 v34, v68, v69
    v_cvt_pk_bf16_f32 v35, v70, v71
    v_cvt_pk_bf16_f32 v36, v72, v73
    v_cvt_pk_bf16_f32 v37, v74, v75
    v_cvt_pk_bf16_f32 v38, v76, v77
    v_cvt_pk_bf16_f32 v39, v78, v79
    v_cvt_pk_bf16_f32 v40, v80, v81
    v_cvt_pk_bf16_f32 v41, v82, v83
    v_cvt_pk_bf16_f32 v42, v84, v85
    v_cvt_pk_bf16_f32 v43, v86, v87
    v_cvt_pk_bf16_f32 v44, v88, v89
    v_cvt_pk_bf16_f32 v45, v90, v91
    v_cvt_pk_bf16_f32 v46, v92, v93
    v_cvt_pk_bf16_f32 v47, v94, v95
    v_mfma_f32_32x32x16_bf16 v[208:223], v[32:35], v[160:163], 0
    s_add_u32 s33, s32, 1
    v_xor_b32 v8, s32, v11
    v_lshl_add_u32 v232, v8, 5, v10
    v_xor_b32_e64 v8, s33, v11
    v_lshl_add_u32 v233, v8, 5, v10
    v_add_u32 v234, 127296, v232
    v_mfma_f32_32x32x16_bf16 v[208:223], v[36:39], v[164:167], v[208:223]
    v_cvt_pk_bf16_f32 v48, v96, v97
    v_cvt_pk_bf16_f32 v49, v98, v99
    v_cvt_pk_bf16_f32 v50, v100, v101
    v_cvt_pk_bf16_f32 v51, v102, v103
    v_cvt_pk_bf16_f32 v52, v104, v105
    v_cvt_pk_bf16_f32 v53, v106, v107
    v_cvt_pk_bf16_f32 v54, v108, v109
    v_cvt_pk_bf16_f32 v55, v110, v111
    v_mfma_f32_32x32x16_bf16 v[208:223], v[40:43], v[168:171], v[208:223]
    v_add_u32 v235, 127296, v233
    v_and_b32_e64 v8, 15, v1
    v_bfe_u32 v10, v1, 1, 3
    v_xor_b32 v10, v10, v9
    v_lshlrev_b32 v10, 4, v10
    v_lshl_add_u32 v8, v8, 7, v10
    v_mfma_f32_32x32x16_bf16 v[208:223], v[44:47], v[172:175], v[208:223]
    v_cvt_pk_bf16_f32 v56, v112, v113
    v_cvt_pk_bf16_f32 v57, v114, v115
    v_cvt_pk_bf16_f32 v58, v116, v117
    v_cvt_pk_bf16_f32 v59, v118, v119
    v_cvt_pk_bf16_f32 v60, v120, v121
    v_cvt_pk_bf16_f32 v61, v122, v123
    v_cvt_pk_bf16_f32 v62, v124, v125
    v_cvt_pk_bf16_f32 v63, v126, v127
    v_mfma_f32_32x32x16_bf16 v[208:223], v[48:51], v[176:179], v[208:223]
    s_lshl_b32 s32, s58, 13
    s_add_u32 s32, s32, 61760
    v_add_u32 v236, s32, v8
    v_xor_b32 v8, 64, v8
    v_add_u32 v237, s32, v8
    v_mfma_f32_32x32x16_bf16 v[208:223], v[52:55], v[180:183], v[208:223]
    v_mfma_f32_32x32x16_bf16 v[208:223], v[56:59], v[184:187], v[208:223]
    v_mfma_f32_32x32x16_bf16 v[208:223], v[60:63], v[188:191], v[208:223]
    s_lshl_b32 s32, s57, 12
    s_add_u32 s32, s32, 153920
    v_lshl_add_u32 v8, v1, 4, s32
    s_lshl_b32 s32, s57, 2
    s_add_u32 s32, s32, 162896
    s_cmp_gt_u32 s3, 3
    s_cbranch_scc1 L_k6
    s_nop 6
    s_nop 0
    ds_write_b128 v8, v[208:211] offset:0
    ds_write_b128 v8, v[212:215] offset:1024
    ds_write_b128 v8, v[216:219] offset:2048
    ds_write_b128 v8, v[220:223] offset:3072
    v_mov_b32 v251, s32
    s_mov_b64 exec, 1
    ds_write_b32 v251, v253
    s_mov_b64 exec, -1
    s_setprio 0
    v_mov_b32 v8, v232
    v_mov_b32 v9, v233
    v_mov_b32 v10, v234
    v_mov_b32 v11, v235
    v_mov_b32 v12, v236
    v_mov_b32 v13, v237
    v_mov_b32 v240, 0
    v_mov_b32 v241, 0
    s_branch L_gsetup
L_k6:
    s_cmp_lg_u32 s3, 6
    s_cbranch_scc1 L_k1
    s_waitcnt lgkmcnt(0)
    s_add_u32 s4, s6, 0x7f4a7c15
    s_addc_u32 s5, s7, 0x9e3779b9
    v_mov_b32 v24, s4
    v_mov_b32 v25, s5
    v_mov_b32 v28, 163008
    s_mov_b64 exec, 1
    ds_write_b64 v28, v[24:25]
    s_mov_b64 exec, -1
    v_mov_b32 v251, 162912
    s_mov_b64 exec, 1
    ds_write_b32 v251, v253
    s_mov_b64 exec, -1
L_k1:
    v_and_b32 v16, 31, v1
    v_lshlrev_b32 v16, 4, v16
    v_lshrrev_b32 v17, 5, v1
    v_lshlrev_b32 v17, 9, v17
    v_add_u32_e64 v16, v16, v17
    v_sub_u32 v16, 1008, v16
    v_add_u32 v16, s59, v16
    v_lshrrev_b32 v17, 2, v1
    v_mul_u32_u24 v17, 4160, v17
    v_and_b32 v18, 3, v1
    v_lshlrev_b32 v18, 4, v18
    v_add3_u32 v17, v17, v18, s59
    v_mov_b32 v20, 0
    v_mov_b32 v21, 0
    v_mov_b32 v22, 0
    v_mov_b32 v23, 0
    v_mov_b32_e64 v18, 0
    v_writelane_b32 v18, s45, 0
    v_mov_b32_e64 v250, s32
    ds_read_b32 v251, v250
    s_waitcnt lgkmcnt(0)
    v_cmp_ne_u32 vcc, 0, v251
    s_getpc_b64 s[62:63]
    s_cbranch_vccnz L_stub
    ds_read_b128 v[128:131], v8 offset:0
    ds_read_b128 v[132:135], v8 offset:1024
    ds_read_b128 v[136:139], v8 offset:2048
    ds_read_b128 v[140:143], v8 offset:3072
    s_waitcnt lgkmcnt(0)
    v_add_f32 v208, v208, v128
    v_add_f32 v209, v209, v129
    v_add_f32 v210, v210, v130
    v_add_f32 v211, v211, v131
    v_add_f32 v212, v212, v132
    v_add_f32 v213, v213, v133
    v_add_f32 v214, v214, v134
    v_add_f32 v215, v215, v135
    v_add_f32 v216, v216, v136
    v_add_f32 v217, v217, v137
    v_add_f32 v218, v218, v138
    v_add_f32 v219, v219, v139
    v_add_f32 v220, v220, v140
    v_add_f32 v221, v221, v141
    v_add_f32 v222, v222, v142
    v_add_f32 v223, v223, v143
    v_and_b32 v19, 1, v1
    v_cmp_eq_u32 vcc, 1, v19
    v_add_f32 v208, v208, v18
    v_cvt_pk_bf16_f32 v64, v215, v214
    v_cvt_pk_bf16_f32 v65, v213, v212
    v_cvt_pk_bf16_f32 v66, v211, v210
    v_cvt_pk_bf16_f32 v67, v209, v208
    v_cvt_pk_bf16_f32 v80, v218, v218
    v_cvt_pk_bf16_f32 v81, v217, v217
    v_cvt_pk_bf16_f32 v82, v217, v216
    v_cvt_pk_bf16_f32 v83, v216, v216
    v_cndmask_b32_e64 v19, v219, v220, vcc
    v_cvt_pk_bf16_f32 v96, v220, v220
    v_cvt_pk_bf16_f32 v97, v220, v19
    v_cvt_pk_bf16_f32 v98, v219, v219
    v_cvt_pk_bf16_f32 v99, v219, v219
    v_cndmask_b32_e64 v19, v221, v222, vcc
    v_cvt_pk_bf16_f32 v112, v222, v222
    v_cvt_pk_bf16_f32 v113, v222, v19
    v_cvt_pk_bf16_f32 v114, v221, v221
    v_cvt_pk_bf16_f32 v115, v221, v221
    v_mov_b32 v128, 0
    v_mov_b32 v129, 0
    v_mov_b32_dpp v130, v64 wave_ror:1 row_mask:0xf bank_mask:0xf
    v_mov_b32_dpp v131, v65 wave_ror:1 row_mask:0xf bank_mask:0xf
    v_mov_b32_dpp v132, v80 wave_ror:1 row_mask:0xf bank_mask:0xf
    v_mov_b32_dpp v133, v81 wave_ror:1 row_mask:0xf bank_mask:0xf
    v_mov_b32_dpp v134, v96 wave_ror:1 row_mask:0xf bank_mask:0xf
    v_mov_b32_dpp v135, v97 wave_ror:1 row_mask:0xf bank_mask:0xf
    v_mov_b32_dpp v128, v64 wave_shr:1 row_mask:0xf bank_mask:0xf
    v_mov_b32_dpp v129, v65 wave_shr:1 row_mask:0xf bank_mask:0xf
    v_mov_b32_dpp v130, v80 wave_shr:1 row_mask:0xf bank_mask:0xf
    v_mov_b32_dpp v131, v81 wave_shr:1 row_mask:0xf bank_mask:0xf
    v_mov_b32_dpp v132, v96 wave_shr:1 row_mask:0xf bank_mask:0xf
    v_mov_b32_dpp v133, v97 wave_shr:1 row_mask:0xf bank_mask:0xf
    v_mov_b32_dpp v134, v112 wave_shr:1 row_mask:0xf bank_mask:0xf
    v_mov_b32_dpp v135, v113 wave_shr:1 row_mask:0xf bank_mask:0xf
    v_alignbit_b32 v68, v65, v64, 16
    v_alignbit_b32 v69, v66, v65, 16
    v_alignbit_b32 v70, v67, v66, 16
    v_alignbit_b32 v71, v128, v67, 16
    v_mov_b32 v72, v65
    v_mov_b32 v73, v66
    v_mov_b32 v74, v67
    v_mov_b32 v75, v128
    v_alignbit_b32 v76, v66, v65, 16
    v_alignbit_b32 v77, v67, v66, 16
    v_alignbit_b32 v78, v128, v67, 16
    v_alignbit_b32 v79, v129, v128, 16
    v_alignbit_b32 v84, v81, v80, 16
    v_alignbit_b32 v85, v82, v81, 16
    v_alignbit_b32 v86, v83, v82, 16
    v_alignbit_b32 v87, v130, v83, 16
    v_mov_b32 v88, v81
    v_mov_b32 v89, v82
    v_mov_b32 v90, v83
    v_mov_b32 v91, v130
    v_alignbit_b32 v92, v82, v81, 16
    v_alignbit_b32 v93, v83, v82, 16
    v_alignbit_b32 v94, v130, v83, 16
    v_alignbit_b32 v95, v131, v130, 16
    v_alignbit_b32 v100, v97, v96, 16
    v_alignbit_b32 v101, v98, v97, 16
    v_alignbit_b32 v102, v99, v98, 16
    v_alignbit_b32 v103, v132, v99, 16
    v_mov_b32 v104, v97
    v_mov_b32 v105, v98
    v_mov_b32 v106, v99
    v_mov_b32 v107, v132
    v_alignbit_b32 v108, v98, v97, 16
    v_alignbit_b32 v109, v99, v98, 16
    v_alignbit_b32 v110, v132, v99, 16
    v_alignbit_b32 v111, v133, v132, 16
    v_alignbit_b32 v116, v113, v112, 16
    v_alignbit_b32 v117, v114, v113, 16
    v_alignbit_b32 v118, v115, v114, 16
    v_alignbit_b32 v119, v134, v115, 16
    v_mov_b32 v120, v113
    v_mov_b32 v121, v114
    v_mov_b32 v122, v115
    v_mov_b32 v123, v134
    v_alignbit_b32 v124, v114, v113, 16
    v_alignbit_b32 v125, v115, v114, 16
    v_alignbit_b32 v126, v134, v115, 16
    v_alignbit_b32 v127, v135, v134, 16
    s_setprio 0
    s_cmp_eq_u32 s57, 1
    s_cbranch_scc1 L_k2
    v_and_b32 v250, 1, v1
    v_lshlrev_b32_e64 v250, 2, v250
    v_add_u32 v250, 163096, v250
    ds_read_b32 v251, v250
    s_waitcnt lgkmcnt(0)
    v_cmp_ne_u32 vcc, 0, v251
    s_getpc_b64 s[62:63]
    s_cbranch_vccnz L_stub
    s_and_b32 s33, s53, 0xf8
    s_add_u32 s32, s33, s53
    s_lshl_b32 s32, s32, 4
    s_add_u32 s32, s32, 4096
    s_mov_b64 s[6:7], s[4:5]
    s_atomic_swap_x2 s[6:7], s[94:95], s32
L_k2:
    s_cmp_eq_u32 s57, 0
    s_cbranch_scc1 L_k5
    v_mov_b32 v250, 162912
    ds_read_b32 v251, v250
    s_waitcnt lgkmcnt(0)
    v_cmp_ne_u32_e64 vcc, 0, v251
    s_getpc_b64 s[62:63]
    s_cbranch_vccnz L_stub
    v_mov_b32 v250, 163008
    ds_read_b64 v[250:251], v250
    s_waitcnt lgkmcnt(0)
    v_readfirstlane_b32 s4, v250
    v_readfirstlane_b32 s5, v251
    s_nop 1
    s_and_b32 s32, s49, 0
    s_lshl_b32 s32, s32, 5
    s_add_u32 s32, s32, 162400
    v_lshlrev_b32 v244, 7, v1
    s_and_b32 s34, s49, 1
    s_mul_i32 s34, s34, 704512
    s_lshr_b32 s35, s49, 1
    s_mul_i32 s35, s35, 0
    s_add_u32 s34, s34, s35
    s_add_u32 s34, s34, 262144
    v_and_b32 v245, 0x38, v1
    v_add_lshl_u32 v245, v245, v1, 4
    s_mov_b32 s36, 4096
    s_mov_b32 s37, 8192
    v_and_b32_e64 v250, 1, v1
    v_lshl_add_u32 v250, v250, 2, s32
    ds_read_b32 v251, v250
    s_waitcnt lgkmcnt(0)
    v_cmp_ne_u32_e64 vcc, 0, v251
    s_getpc_b64 s[62:63]
    s_cbranch_vccnz L_stub
    s_mov_b32 s46, 0
L_gp_1:
    buffer_load_dwordx2 v[224:225], v245, s[24:27], s36 offen offset:0 sc1
    buffer_load_dwordx2 v[238:239], v245, s[24:27], s36 offen offset:2048 sc1
    buffer_load_dwordx2 v[240:241], v245, s[24:27], s37 offen offset:0 sc1
    buffer_load_dwordx2 v[242:243], v245, s[24:27], s37 offen offset:2048 sc1
    s_add_u32 s46, s46, 1
    s_cmp_lt_u32 s46, 30000
    s_cselect_b64 s[42:43], -1, 0
    s_waitcnt vmcnt(0)
    v_cmp_ne_u64 vcc, s[4:5], v[224:225]
    v_cmp_ne_u64 s[38:39], s[4:5], v[238:239]
    s_nop 0
    s_or_b64 vcc, vcc, s[38:39]
    v_cmp_ne_u64 s[38:39], s[4:5], v[240:241]
    s_nop 0
    s_or_b64 vcc, vcc, s[38:39]
    v_cmp_ne_u64 s[38:39], s[4:5], v[242:243]
    s_nop 0
    s_or_b64 vcc, vcc, s[38:39]
    s_nop 0
    s_and_b64 vcc, vcc, s[42:43]
    s_cbranch_scc1 L_gp_1
    s_mov_b32 m0, 162920
    s_mov_b64 exec, 1
    buffer_load_dword v252, s[8:11], 0 offen offset:0 lds
    s_mov_b64 exec, -1
    s_lshl_b32 s32, s51, 14
    s_add_u32 s32, s32, 262144
    v_lshlrev_b32_e64 v40, 4, v1
    buffer_load_dwordx4 v[144:147], v40, s[24:27], s32 offen offset:0 sc1
    buffer_load_dwordx4 v[148:151], v40, s[24:27], s32 offen offset:1024 sc1
    buffer_load_dwordx4 v[152:155], v40, s[24:27], s32 offen offset:2048 sc1
    buffer_load_dwordx4 v[156:159], v40, s[24:27], s32 offen offset:3072 sc1
    s_add_u32 s32, s32, 4096
    buffer_load_dwordx4 v[160:163], v40, s[24:27], s32 offen offset:0 sc1
    buffer_load_dwordx4 v[164:167], v40, s[24:27], s32 offen offset:1024 sc1
    buffer_load_dwordx4 v[168:171], v40, s[24:27], s32 offen offset:2048 sc1
    buffer_load_dwordx4 v[172:175], v40, s[24:27], s32 offen offset:3072 sc1
    s_add_u32 s32, s32, 4096
    buffer_load_dwordx4 v[176:179], v40, s[24:27], s32 offen offset:0 sc1
    buffer_load_dwordx4 v[180:183], v40, s[24:27], s32 offen offset:1024 sc1
    buffer_load_dwordx4 v[184:187], v40, s[24:27], s32 offen offset:2048 sc1
    buffer_load_dwordx4 v[188:191], v40, s[24:27], s32 offen offset:3072 sc1
    s_add_u32 s32, s32, 4096
    buffer_load_dwordx4 v[192:195], v40, s[24:27], s32 offen offset:0 sc1
    buffer_load_dwordx4 v[196:199], v40, s[24:27], s32 offen offset:1024 sc1
    buffer_load_dwordx4 v[200:203], v40, s[24:27], s32 offen offset:2048 sc1
    buffer_load_dwordx4 v[204:207], v40, s[24:27], s32 offen offset:3072 sc1
    v_add_u32 v40, 153920, v40
    s_waitcnt vmcnt(0)
    v_add_f32 v144, v144, v176
    v_add_f32 v145, v145, v177
    v_add_f32 v146, v146, v178
    v_add_f32 v147, v147, v179
    v_add_f32 v148, v148, v180
    v_add_f32 v149, v149, v181
    v_add_f32 v150, v150, v182
    v_add_f32 v151, v151, v183
    v_add_f32 v152, v152, v184
    v_add_f32 v153, v153, v185
    v_add_f32 v154, v154, v186
    v_add_f32 v155, v155, v187
    v_add_f32 v156, v156, v188
    v_add_f32 v157, v157, v189
    v_add_f32 v158, v158, v190
    v_add_f32 v159, v159, v191
    v_add_f32 v160, v160, v192
    v_add_f32 v161, v161, v193
    v_add_f32 v162, v162, v194
    v_add_f32 v163, v163, v195
    v_add_f32 v164, v164, v196
    v_add_f32 v165, v165, v197
    v_add_f32 v166, v166, v198
    v_add_f32 v167, v167, v199
    v_add_f32 v168, v168, v200
    v_add_f32 v169, v169, v201
    v_add_f32 v170, v170, v202
    v_add_f32 v171, v171, v203
    v_add_f32 v172, v172, v204
    v_add_f32 v173, v173, v205
    v_add_f32 v174, v174, v206
    v_add_f32 v175, v175, v207
    v_add_f32 v144, v144, v160
    v_add_f32 v145, v145, v161
    v_add_f32 v146, v146, v162
    v_add_f32 v147, v147, v163
    v_add_f32 v148, v148, v164
    v_add_f32 v149, v149, v165
    v_add_f32 v150, v150, v166
    v_add_f32 v151, v151, v167
    v_add_f32 v152, v152, v168
    v_add_f32 v153, v153, v169
    v_add_f32 v154, v154, v170
    v_add_f32 v155, v155, v171
    v_add_f32 v156, v156, v172
    v_add_f32 v157, v157, v173
    v_add_f32 v158, v158, v174
    v_add_f32 v159, v159, v175
    v_add_f32 v144, v144, v152
    v_add_f32 v145, v145, v153
    v_add_f32 v146, v146, v154
    v_add_f32 v147, v147, v155
    v_add_f32 v148, v148, v156
    v_add_f32 v149, v149, v157
    v_add_f32 v150, v150, v158
    v_add_f32 v151, v151, v159
    v_add_f32 v144, v144, v148
    v_add_f32 v145, v145, v149
    v_add_f32 v146, v146, v150
    v_add_f32_e64 v147, v147, v151
    ds_write_b128 v40, v[144:147]
    s_waitcnt lgkmcnt(0)
    s_mov_b32 m0, 162940
    s_mov_b64 exec, 1
    buffer_load_dword v252, s[8:11], 0 offen offset:0 lds
    s_mov_b64 exec, -1
    s_cmp_lg_u32 s2, 0
    s_cbranch_scc1 L_k3
    s_mov_b32 s33, 0
    s_mov_b64 s[6:7], s[4:5]
    s_atomic_swap_x2 s[6:7], s[94:95], s33
L_k3:
    s_setprio 0
    v_and_b32 v10, 3, v1
    v_sub_u32 v10, 3, v10
    v_mul_u32_u24 v10, 4160, v10
    v_bfe_u32 v11, v1, 2, 2
    v_lshlrev_b32 v11, 3, v11
    v_sub_u32 v10, v10, v11
    v_and_b32_e64 v12, 48, v1
    s_lshl_b32 s32, s58, 8
    s_sub_u32 s33, s59, s32
    s_add_u32 s33, s33, 280
    v_add3_u32 v8, v10, v12, s33
    v_and_b32 v10, 15, v1
    v_lshrrev_b32 v11, 4, v1
    v_lshl_add_u32 v10, v10, 1, v11
    s_lshl_b32 s32, s58, 4
    s_sub_u32 s32, 30, s32
    v_add_u32_e64 v10, s32, v10
    v_bfe_u32 v11, v10, 3, 1
    v_xor_b32_e64 v11, s57, v11
    v_lshl_add_u32 v11, v10, 1, v11
    v_lshlrev_b32_e64 v11, 4, v11
    v_add_u32 v4, 144704, v11
    v_subrev_u32_e64 v10, 4, v10
    v_bfe_u32 v11, v10, 3, 1
    v_xor_b32_e64 v11, s57, v11
    v_lshl_add_u32 v11, v10, 1, v11
    v_lshlrev_b32_e64 v11, 4, v11
    v_add_u32 v5, 144704, v11
    v_subrev_u32_e64 v10, 4, v10
    v_bfe_u32 v11, v10, 3, 1
    v_xor_b32_e64 v11, s57, v11
    v_lshl_add_u32 v11, v10, 1, v11
    v_lshlrev_b32_e64 v11, 4, v11
    v_add_u32 v6, 144704, v11
    v_subrev_u32_e64 v10, 4, v10
    v_bfe_u32 v11, v10, 3, 1
    v_xor_b32_e64 v11, s57, v11
    v_lshl_add_u32 v11, v10, 1, v11
    v_lshlrev_b32_e64 v11, 4, v11
    v_add_u32 v7, 144704, v11
    v_and_b32 v250, 3, v1
    v_lshlrev_b32 v250, 2, v250
    v_add_u32 v250, 162608, v250
    ds_read_b32 v251, v250
    s_waitcnt lgkmcnt(0)
    v_cmp_ne_u32 vcc, 0, v251
    s_getpc_b64 s[62:63]
    s_cbranch_vccnz L_stub
    ds_write_b128 v16, v[64:67] offset:3072
    ds_write_b128 v16, v[68:71] offset:7232
    ds_write_b128 v16, v[72:75] offset:11392
    ds_write_b128 v16, v[76:79] offset:15552
    ds_write_b128 v16, v[80:83] offset:2048
    ds_write_b128 v16, v[84:87] offset:6208
    ds_write_b128 v16, v[88:91] offset:10368
    ds_write_b128 v16, v[92:95] offset:14528
    ds_write_b128 v16, v[96:99] offset:1024
    ds_write_b128 v16, v[100:103] offset:5184
    ds_write_b128 v16, v[104:107] offset:9344
    ds_write_b128 v16, v[108:111] offset:13504
    ds_write_b128 v16, v[112:115] offset:0
    ds_write_b128 v16, v[116:119] offset:4160
    ds_write_b128 v16, v[120:123] offset:8320
    ds_write_b128 v16, v[124:127] offset:12480
    s_mov_b64 exec, 0xffff
    ds_write_b128 v17, v[20:23] offset:4096
    s_mov_b64 exec, -1
    s_lshl_b32 s32, s57, 9
    s_add_u32 s32, s32, 144704
    v_lshl_add_u32 v28, v1, 3, s32
    ds_write_b64 v28, v[20:21]
    s_lshl_b32 s32, s57, 2
    s_add_u32 s32, s32, 162880
    v_mov_b32_e64 v251, s32
    s_mov_b64 exec, 1
    ds_write_b32 v251, v253
    s_mov_b64 exec, -1
    s_branch L_conv
    .p2align 6
L_g:
    s_setprio 2
    s_lshr_b32 s32, s48, 1
    s_and_b32 s33, s48, 1
    s_and_b32 s34, s49, 3
    s_lshr_b32 s35, s49, 2
    s_and_b32 s56, s49, 7
    s_lshr_b32 s55, s53, 3
    s_mul_i32 s52, s34, 0
    s_mul_i32 s51, s33, 7
    s_add_u32 s51, s51, s35
    s_lshl_b32 s36, s33, 1
    s_add_u32 s36, s36, s34
    s_cmp_ge_u32 s49, 28
    s_cselect_b32 s51, 14, s51
    s_cselect_b32 s34, s36, s34
    s_and_b32 s34, s34, 3
    s_lshl_b32 s50, s32, 2
    s_add_u32 s50, s50, s34
    s_bfe_u32 s58, s3, 0x10001
    s_mov_b32 s10, 0x200000
    s_mov_b32 s11, 0x20000
    s_mov_b64 s[8:9], s[64:65]
    s_mul_i32 s59, s57, 16896
    s_add_u32 s59, s59, 110912
    s_lshl_b32 s60, s57, 4
    s_add_u32 s60, s60, 144704
    s_mov_b64 s[20:21], s[88:89]
    s_mov_b32 s22, 1409024
    s_mov_b32 s23, 0x20000
    s_mov_b64 s[24:25], s[94:95]
    s_mov_b32 s26, 268435456
    s_mov_b32 s27, 0x20000
    s_mov_b64 s[28:29], s[90:91]
    s_nop 0
    s_mov_b32 s30, 2097152
    s_mov_b32 s31, 0x20000
    v_mov_b32 v252, 0x7ff00000
    v_mov_b32 v253, 0
    s_barrier
    s_cmp_eq_u32 s57, 0
    s_cselect_b64 s[12:13], s[84:85], s[86:87]
    s_mov_b32 s14, 1409024
    s_mov_b32 s15, 0x20000
    s_cmp_eq_u32 s51, 14
    s_cselect_b32 s36, 4, 12
    s_cmp_ge_u32 s49, 30
    s_cselect_b32 s36, 0, s36
    v_lshrrev_b32_e64 v9, 4, v1
    v_mul_u32_u24 v9, 2752, v9
    v_and_b32 v10, 15, v1
    v_cmp_le_u32 vcc, s36, v10
    v_lshl_add_u32 v9, v10, 4, v9
    s_mul_i32 s34, s50, 88064
    v_cndmask_b32_e64 v9, v9, v252, vcc
    s_mul_i32 s35, s51, 192
    s_add_u32 s34, s34, s35
    s_nop 0
    buffer_load_dwordx4 v[144:147], v9, s[12:15], s34 offen
    s_add_u32 s34, s34, 11008
    buffer_load_dwordx4 v[148:151], v9, s[12:15], s34 offen
    s_add_u32 s34, s34, 11008
    buffer_load_dwordx4 v[152:155], v9, s[12:15], s34 offen
    s_add_u32 s34, s34, 11008
    buffer_load_dwordx4 v[156:159], v9, s[12:15], s34 offen
    s_add_u32 s34, s34, 11008
    buffer_load_dwordx4 v[160:163], v9, s[12:15], s34 offen
    s_add_u32 s34, s34, 11008
    buffer_load_dwordx4 v[164:167], v9, s[12:15], s34 offen
    s_add_u32 s34, s34, 11008
    buffer_load_dwordx4 v[168:171], v9, s[12:15], s34 offen
    s_add_u32 s34, s34, 11008
    buffer_load_dwordx4 v[172:175], v9, s[12:15], s34 offen
    s_lshl_b32 s70, s51, 4
    s_add_u32 s70, s70, s50
    s_add_u32 s35, s53, 256
    s_cmp_ge_u32 s49, 30
    s_cselect_b32 s70, s35, s70
    s_lshl_b32 s70, s70, 1
    s_add_u32 s70, s70, s57
    s_lshl_b32 s70, s70, 9
    s_add_u32 s70, s70, 262144
    v_lshrrev_b32 v41, 4, v1
    v_bfe_u32 v42, v1, 2, 2
    v_lshl_add_u32 v42, v41, 3, v42
    v_mul_u32_u24 v42, 192, v42
    v_and_b32_e64 v43, 3, v1
    v_lshl_add_u32 v42, v43, 3, v42
    v_and_b32 v43, 1, v41
    s_mul_i32 s32, s57, 3
    s_add_u32 s33, s32, 1
    v_xor_b32 v40, s32, v43
    v_lshl_add_u32 v8, v40, 5, v42
    v_xor_b32_e64 v40, s33, v43
    v_lshl_add_u32 v9, v40, 5, v42
    v_add_u32 v10, 127296, v8
    v_add_u32 v11, 127296, v9
    v_and_b32_e64 v40, 15, v1
    v_bfe_u32 v42, v1, 1, 3
    v_xor_b32 v42, v42, v41
    v_lshlrev_b32 v42, 4, v42
    v_lshl_add_u32 v40, v40, 7, v42
    s_lshl_b32 s32, s58, 13
    s_add_u32 s32, s32, 61760
    v_add_u32 v12, s32, v40
    v_xor_b32 v40, 64, v40
    v_add_u32 v13, s32, v40
    v_lshlrev_b32 v240, 4, v1
    v_lshrrev_b32 v24, 3, v1
    v_add_u32 v24, s53, v24
    v_and_b32 v24, 7, v24
    v_cmp_eq_u32_e64 vcc, 3, v24
    s_bfe_u32 s32, s53, 0x20003
    s_lshl_b32 s32, s32, 7
    s_add_u32 s32, s32, 20971648
    v_add_u32 v24, s32, v240
    v_cndmask_b32_e64 v241, v240, v24, vcc
    s_and_b32 s39, s3, 3
    s_lshl_b32 s39, s39, 2
    s_add_u32 s39, s39, 162128
    v_mov_b32 v120, 0x3f803f80
    v_mov_b32 v121, 0x3f80
    v_mov_b32 v122, 0x3f800000
    s_lshl_b32 s32, s57, 12
    s_add_u32 s32, s32, 115008
    v_lshl_add_u32 v123, v1, 4, s32
    s_lshl_b32 s32, s57, 11
    s_add_u32 s32, s32, 115008
    v_lshl_add_u32 v124, v1, 4, s32
    v_lshrrev_b32_e64 v125, 4, v1
    s_lshl_b32 s32, s57, 5
    s_add_u32 s32, s32, 123200
    v_lshl_add_u32 v125, v125, 3, s32
    v_lshlrev_b32_e64 v240, 4, v1
    v_add_u32 v126, 123200, v240
    s_mul_i32 s67, s53, 8320
    s_add_u32 s67, s67, 1048576
    s_lshl_b32 s66, s57, 12
    s_add_u32 s66, s66, s67
    s_add_u32 s67, s67, 8192
    s_cmp_eq_u32 s57, 0
    s_cselect_b64 s[68:69], 15, 0
    s_waitcnt vmcnt(11)
    v_dot2_f32_bf16 v112, v64, v120, 0
    s_waitcnt vmcnt(10)
    v_dot2_f32_bf16 v113, v68, v120, 0
    s_waitcnt vmcnt(9)
    v_dot2_f32_bf16 v114, v72, v120, 0
    s_waitcnt vmcnt(8)
    v_dot2_f32_bf16 v115, v76, v120, 0
    v_dot2_f32_bf16 v112, v65, v120, v112
    v_dot2_f32_bf16 v113, v69, v120, v113
    v_dot2_f32_bf16 v114, v73, v120, v114
    v_dot2_f32_bf16 v115, v77, v120, v115
    v_dot2_f32_bf16 v112, v66, v120, v112
    v_dot2_f32_bf16 v113, v70, v120, v113
    v_dot2_f32_bf16 v114, v74, v120, v114
    v_dot2_f32_bf16 v115, v78, v120, v115
    v_dot2_f32_bf16 v112, v67, v120, v112
    v_dot2_f32_bf16 v113, v71, v120, v113
    v_dot2_f32_bf16 v114, v75, v120, v114
    v_dot2_f32_bf16 v115, v79, v120, v115
    s_nop 2
    v_permlane32_swap_b32 v112, v114
    v_permlane32_swap_b32 v113, v115
    v_add_f32 v112, v112, v114
    v_add_f32 v113, v113, v115
    s_nop 1
    v_permlane16_swap_b32 v112, v113
    v_add_f32_e64 v112, v112, v113
    s_nop 1
    v_add_f32_dpp v112, v112, v112 row_ror:8 row_mask:0xf bank_mask:0xf
    s_nop 1
    v_add_f32_dpp v112, v112, v112 row_ror:4 row_mask:0xf bank_mask:0xf
    s_nop 1
    v_add_f32_dpp v112, v112, v112 row_ror:2 row_mask:0xf bank_mask:0xf
    s_nop 1
    v_add_f32_dpp v112, v112, v112 row_ror:1 row_mask:0xf bank_mask:0xf
    v_mul_f32 v118, 0x3b000000, v112
    v_mov_b32 v116, v118
    v_cvt_pk_bf16_f32 v116, v116, v116
    v_and_b32 v116, 0xffff0000, v116
    v_xor_b32 v115, 0x80000000, v116
    v_sub_f32_e64 v118, v118, v116
    v_readlane_b32 s32, v115, 0
    v_readlane_b32 s33, v115, 16
    v_readlane_b32 s34, v115, 32
    v_readlane_b32 s35, v115, 48
    v_dot2_f32_bf16 v80, v64, v121, s32
    v_dot2_f32_bf16 v81, v64, v122, s32
    v_dot2_f32_bf16 v82, v65, v121, s32
    v_dot2_f32_bf16 v83, v65, v122, s32
    v_dot2_f32_bf16 v84, v66, v121, s32
    v_dot2_f32_bf16 v85, v66, v122, s32
    v_dot2_f32_bf16 v86, v67, v121, s32
    v_dot2_f32_bf16 v87, v67, v122, s32
    v_dot2_f32_bf16 v88, v68, v121, s33
    v_dot2_f32_bf16 v89, v68, v122, s33
    v_dot2_f32_bf16 v90, v69, v121, s33
    v_dot2_f32_bf16 v91, v69, v122, s33
    v_dot2_f32_bf16 v92, v70, v121, s33
    v_dot2_f32_bf16 v93, v70, v122, s33
    v_dot2_f32_bf16 v94, v71, v121, s33
    v_dot2_f32_bf16 v95, v71, v122, s33
    v_dot2_f32_bf16 v96, v72, v121, s34
    v_dot2_f32_bf16 v97, v72, v122, s34
    v_dot2_f32_bf16 v98, v73, v121, s34
    v_dot2_f32_bf16 v99, v73, v122, s34
    v_dot2_f32_bf16 v100, v74, v121, s34
    v_dot2_f32_bf16 v101, v74, v122, s34
    v_dot2_f32_bf16 v102, v75, v121, s34
    v_dot2_f32_bf16 v103, v75, v122, s34
    v_dot2_f32_bf16 v104, v76, v121, s35
    v_dot2_f32_bf16 v105, v76, v122, s35
    v_dot2_f32_bf16 v106, v77, v121, s35
    v_dot2_f32_bf16 v107, v77, v122, s35
    v_dot2_f32_bf16 v108, v78, v121, s35
    v_dot2_f32_bf16 v109, v78, v122, s35
    v_dot2_f32_bf16 v110, v79, v121, s35
    v_dot2_f32_bf16 v111, v79, v122, s35
    v_pk_mul_f32 v[64:65], v[80:81], v[80:81]
    v_pk_mul_f32 v[66:67], v[88:89], v[88:89]
    v_pk_mul_f32 v[68:69], v[96:97], v[96:97]
    v_pk_mul_f32 v[70:71], v[104:105], v[104:105]
    v_pk_fma_f32 v[64:65], v[82:83], v[82:83], v[64:65]
    v_pk_fma_f32 v[66:67], v[90:91], v[90:91], v[66:67]
    v_pk_fma_f32 v[68:69], v[98:99], v[98:99], v[68:69]
    v_pk_fma_f32 v[70:71], v[106:107], v[106:107], v[70:71]
    v_pk_fma_f32 v[64:65], v[84:85], v[84:85], v[64:65]
    v_pk_fma_f32 v[66:67], v[92:93], v[92:93], v[66:67]
    v_pk_fma_f32 v[68:69], v[100:101], v[100:101], v[68:69]
    v_pk_fma_f32 v[70:71], v[108:109], v[108:109], v[70:71]
    v_pk_fma_f32 v[64:65], v[86:87], v[86:87], v[64:65]
    v_pk_fma_f32 v[66:67], v[94:95], v[94:95], v[66:67]
    v_pk_fma_f32 v[68:69], v[102:103], v[102:103], v[68:69]
    v_pk_fma_f32 v[70:71], v[110:111], v[110:111], v[70:71]
    v_add_f32 v112, v64, v65
    v_add_f32 v113, v66, v67
    v_add_f32 v114, v68, v69
    v_add_f32 v115, v70, v71
    s_nop 2
    v_permlane32_swap_b32 v112, v114
    v_permlane32_swap_b32 v113, v115
    v_add_f32 v112, v112, v114
    v_add_f32 v113, v113, v115
    s_nop 1
    v_permlane16_swap_b32 v112, v113
    v_add_f32_e64 v112, v112, v113
    s_nop 1
    v_add_f32_dpp v112, v112, v112 row_ror:8 row_mask:0xf bank_mask:0xf
    s_nop 1
    v_add_f32_dpp v112, v112, v112 row_ror:4 row_mask:0xf bank_mask:0xf
    s_nop 1
    v_add_f32_dpp v112, v112, v112 row_ror:2 row_mask:0xf bank_mask:0xf
    s_nop 1
    s_nop 0
    v_add_f32_dpp v112, v112, v112 row_ror:1 row_mask:0xf bank_mask:0xf
    v_mul_f32 v112, 0x3b000000, v112
    v_fma_f32 v112, -v118, v118, v112
    v_max_f32_e64 v112, 0, v112
    v_cvt_pk_bf16_f32 v112, v112, v112
    v_and_b32 v112, 0xffff0000, v112
    v_add_f32 v112, 0x3727c5ac, v112
    v_cvt_pk_bf16_f32 v112, v112, v112
    v_and_b32 v112, 0xffff0000, v112
    v_sqrt_f32 v112, v112
    s_nop 0
    v_cvt_pk_bf16_f32 v112, v112, v112
    v_and_b32 v112, 0xffff0000, v112
    v_rcp_f32 v117, v112
    s_nop 0
    v_readlane_b32 s72, v117, 0
    v_readlane_b32 s74, v117, 16
    v_readlane_b32 s76, v117, 32
    v_readlane_b32 s78, v117, 48
    v_pk_mul_f32 v[80:81], v[80:81], s[72:73] op_sel_hi:[1,0]
    v_pk_mul_f32 v[82:83], v[82:83], s[72:73] op_sel_hi:[1,0]
    v_pk_mul_f32 v[84:85], v[84:85], s[72:73] op_sel_hi:[1,0]
    v_pk_mul_f32 v[86:87], v[86:87], s[72:73] op_sel_hi:[1,0]
    v_pk_mul_f32 v[88:89], v[88:89], s[74:75] op_sel_hi:[1,0]
    v_pk_mul_f32 v[90:91], v[90:91], s[74:75] op_sel_hi:[1,0]
    v_pk_mul_f32 v[92:93], v[92:93], s[74:75] op_sel_hi:[1,0]
    v_pk_mul_f32 v[94:95], v[94:95], s[74:75] op_sel_hi:[1,0]
    v_pk_mul_f32 v[96:97], v[96:97], s[76:77] op_sel_hi:[1,0]
    v_pk_mul_f32 v[98:99], v[98:99], s[76:77] op_sel_hi:[1,0]
    v_pk_mul_f32 v[100:101], v[100:101], s[76:77] op_sel_hi:[1,0]
    v_pk_mul_f32 v[102:103], v[102:103], s[76:77] op_sel_hi:[1,0]
    v_pk_mul_f32 v[104:105], v[104:105], s[78:79] op_sel_hi:[1,0]
    v_pk_mul_f32 v[106:107], v[106:107], s[78:79] op_sel_hi:[1,0]
    v_pk_mul_f32 v[108:109], v[108:109], s[78:79] op_sel_hi:[1,0]
    v_pk_mul_f32 v[110:111], v[110:111], s[78:79] op_sel_hi:[1,0]
    v_cvt_pk_bf16_f32 v64, v80, v88
    v_cvt_pk_bf16_f32 v65, v96, v104
    v_cvt_pk_bf16_f32 v66, v81, v89
    v_cvt_pk_bf16_f32 v67, v97, v105
    ds_write_b128 v123, v[64:67] offset:0
    v_cvt_pk_bf16_f32 v68, v82, v90
    v_cvt_pk_bf16_f32 v69, v98, v106
    v_cvt_pk_bf16_f32 v70, v83, v91
    v_cvt_pk_bf16_f32 v71, v99, v107
    ds_write_b128 v123, v[68:71] offset:1024
    v_cvt_pk_bf16_f32 v72, v84, v92
    v_cvt_pk_bf16_f32 v73, v100, v108
    v_cvt_pk_bf16_f32 v74, v85, v93
    v_cvt_pk_bf16_f32 v75, v101, v109
    ds_write_b128 v123, v[72:75] offset:2048
    v_cvt_pk_bf16_f32 v76, v86, v94
    v_cvt_pk_bf16_f32 v77, v102, v110
    v_cvt_pk_bf16_f32 v78, v87, v95
    v_cvt_pk_bf16_f32 v79, v103, v111
    ds_write_b128 v123, v[76:79] offset:3072
    s_mov_b32 exec_lo, 0x10001
    s_mov_b32 exec_hi, 0x10001
    ds_write_b64 v125, v[116:117]
    s_mov_b64 exec, -1
    s_add_u32 s32, s39, 928
    v_mov_b32_e64 v251, s32
    s_mov_b64 exec, 1
    ds_write_b32 v251, v253
    s_mov_b64 exec, -1
    s_waitcnt vmcnt(7)
    v_dot2_f32_bf16 v128, v144, v121, 0
    v_dot2_f32_bf16 v129, v144, v122, 0
    v_dot2_f32_bf16 v130, v145, v121, 0
    v_dot2_f32_bf16 v131, v145, v122, 0
    v_dot2_f32_bf16 v132, v146, v121, 0
    v_dot2_f32_bf16 v133, v146, v122, 0
    v_dot2_f32_bf16 v134, v147, v121, 0
    v_dot2_f32_bf16 v135, v147, v122, 0
    s_waitcnt vmcnt(6)
    s_nop 0
    v_dot2_f32_bf16 v128, v148, v121, v128
    v_dot2_f32_bf16 v129, v148, v122, v129
    v_dot2_f32_bf16 v130, v149, v121, v130
    v_dot2_f32_bf16 v131, v149, v122, v131
    v_dot2_f32_bf16 v132, v150, v121, v132
    v_dot2_f32_bf16 v133, v150, v122, v133
    v_dot2_f32_bf16 v134, v151, v121, v134
    v_dot2_f32_bf16 v135, v151, v122, v135
    s_waitcnt vmcnt(5)
    s_nop 0
    v_dot2_f32_bf16 v128, v152, v121, v128
    v_dot2_f32_bf16 v129, v152, v122, v129
    v_dot2_f32_bf16 v130, v153, v121, v130
    v_dot2_f32_bf16 v131, v153, v122, v131
    v_dot2_f32_bf16 v132, v154, v121, v132
    v_dot2_f32_bf16 v133, v154, v122, v133
    v_dot2_f32_bf16 v134, v155, v121, v134
    v_dot2_f32_bf16 v135, v155, v122, v135
    s_waitcnt vmcnt(4)
    s_nop 0
    v_dot2_f32_bf16 v128, v156, v121, v128
    v_dot2_f32_bf16 v129, v156, v122, v129
    v_dot2_f32_bf16 v130, v157, v121, v130
    v_dot2_f32_bf16 v131, v157, v122, v131
    v_dot2_f32_bf16 v132, v158, v121, v132
    v_dot2_f32_bf16 v133, v158, v122, v133
    v_dot2_f32_bf16 v134, v159, v121, v134
    v_dot2_f32_bf16 v135, v159, v122, v135
    s_waitcnt vmcnt(3)
    s_nop 0
    v_dot2_f32_bf16 v128, v160, v121, v128
    v_dot2_f32_bf16 v129, v160, v122, v129
    v_dot2_f32_bf16 v130, v161, v121, v130
    v_dot2_f32_bf16 v131, v161, v122, v131
    v_dot2_f32_bf16 v132, v162, v121, v132
    v_dot2_f32_bf16 v133, v162, v122, v133
    v_dot2_f32_bf16 v134, v163, v121, v134
    v_dot2_f32_bf16 v135, v163, v122, v135
    s_waitcnt vmcnt(2)
    s_nop 0
    v_dot2_f32_bf16 v128, v164, v121, v128
    v_dot2_f32_bf16 v129, v164, v122, v129
    v_dot2_f32_bf16 v130, v165, v121, v130
    v_dot2_f32_bf16 v131, v165, v122, v131
    v_dot2_f32_bf16 v132, v166, v121, v132
    v_dot2_f32_bf16 v133, v166, v122, v133
    v_dot2_f32_bf16 v134, v167, v121, v134
    v_dot2_f32_bf16 v135, v167, v122, v135
    s_waitcnt vmcnt(1)
    s_nop 0
    v_dot2_f32_bf16 v128, v168, v121, v128
    v_dot2_f32_bf16 v129, v168, v122, v129
    v_dot2_f32_bf16 v130, v169, v121, v130
    v_dot2_f32_bf16 v131, v169, v122, v131
    v_dot2_f32_bf16 v132, v170, v121, v132
    v_dot2_f32_bf16 v133, v170, v122, v133
    v_dot2_f32_bf16 v134, v171, v121, v134
    v_dot2_f32_bf16 v135, v171, v122, v135
    s_waitcnt vmcnt(0)
    s_nop 0
    v_dot2_f32_bf16 v128, v172, v121, v128
    v_dot2_f32_bf16 v129, v172, v122, v129
    v_dot2_f32_bf16 v130, v173, v121, v130
    v_dot2_f32_bf16 v131, v173, v122, v131
    v_dot2_f32_bf16 v132, v174, v121, v132
    v_dot2_f32_bf16 v133, v174, v122, v133
    v_dot2_f32_bf16 v134, v175, v121, v134
    v_dot2_f32_bf16 v135, v175, v122, v135
    s_nop 2
    v_permlane32_swap_b32 v128, v132
    v_permlane32_swap_b32 v129, v133
    v_permlane32_swap_b32 v130, v134
    v_permlane32_swap_b32 v131, v135
    v_add_f32 v128, v128, v132
    v_add_f32 v129, v129, v133
    v_add_f32 v130, v130, v134
    v_add_f32 v131, v131, v135
    s_nop 0
    v_permlane16_swap_b32 v128, v130
    v_permlane16_swap_b32 v129, v131
    v_add_f32 v232, v128, v130
    v_add_f32 v233, v129, v131
    v_lshlrev_b32 v234, 3, v1
    v_and_b32 v250, 1, v1
    v_lshlrev_b32_e64 v250, 2, v250
    v_add_u32 v250, 163064, v250
    ds_read_b32 v251, v250
    s_waitcnt lgkmcnt(0)
    v_cmp_ne_u32 vcc, 0, v251
    s_getpc_b64 s[62:63]
    s_cbranch_vccnz L_stub
    ds_read_b64 v[48:49], v124 offset:0
    ds_read_b64 v[50:51], v124 offset:4096
    ds_read_b64 v[52:53], v124 offset:8
    ds_read_b64 v[54:55], v124 offset:4104
    ds_read_b64 v[56:57], v124 offset:1024
    ds_read_b64 v[58:59], v124 offset:5120
    ds_read_b64 v[60:61], v124 offset:1032
    ds_read_b64 v[62:63], v124 offset:5128
    ds_read_b128 v[236:239], v126
    s_mov_b32 m0, s39
    s_waitcnt lgkmcnt(0)
    s_mov_b64 exec, 1
    buffer_load_dword v252, s[8:11], 0 offen offset:992 lds
    s_mov_b64 exec, -1
    s_setprio 0
L_gsetup:
    s_and_b32 s39, s3, 3
    s_lshl_b32 s39, s39, 2
    s_add_u32 s39, s39, 162128
    s_mov_b32 m0, s39
    v_and_b32 v250, 1, v1
    v_lshlrev_b32 v250, 2, v250
    v_add_u32 v250, 162112, v250
    s_cmp_ge_u32 s49, 30
    s_cbranch_scc1 L_spare_g
    ds_read_b32 v251, v250
    s_waitcnt lgkmcnt(0)
    v_cmp_ne_u32 vcc, 0, v251
    s_getpc_b64 s[62:63]
    s_cbranch_vccnz L_stub
    v_add_u32_e64 v250, 32, v250
    ds_read_b128 v[184:187], v12 offset:0
    ds_read_b128 v[188:191], v12 offset:2048
    ds_read_b128 v[192:195], v12 offset:4096
    ds_read_b128 v[196:199], v12 offset:6144
    ds_read_b32 v251, v250
    ds_read_b64_tr_b16 v[160:161], v8 offset:0
    ds_read_b64_tr_b16 v[162:163], v8 offset:768
    ds_read_b64_tr_b16 v[164:165], v8 offset:6176
    ds_read_b64_tr_b16 v[166:167], v8 offset:6944
    ds_read_b64_tr_b16 v[168:169], v9 offset:0
    ds_read_b64_tr_b16 v[170:171], v9 offset:768
    ds_read_b64_tr_b16 v[172:173], v9 offset:6176
    ds_read_b64_tr_b16 v[174:175], v9 offset:6944
    ds_read_b64_tr_b16 v[176:177], v8 offset:64
    ds_read_b64_tr_b16 v[178:179], v8 offset:832
    ds_read_b64_tr_b16 v[180:181], v8 offset:6240
    ds_read_b64_tr_b16 v[182:183], v8 offset:7008
    s_waitcnt lgkmcnt(10)
    v_mfma_f32_16x16x32_bf16 v[64:67], v[160:163], v[184:187], 0
    v_cmp_ne_u32 vcc, 0, v251
    v_mfma_f32_16x16x32_bf16 v[68:71], v[160:163], v[188:191], 0
    v_bfe_u32 v16, v1, 4, 1
    v_lshlrev_b32_e64 v16, 8, v16
    v_mfma_f32_16x16x32_bf16 v[80:83], v[160:163], v[192:195], 0
    s_getpc_b64 s[62:63]
    s_cbranch_vccnz L_stub
    v_mfma_f32_16x16x32_bf16 v[84:87], v[160:163], v[196:199], 0
    ds_read_b128 v[200:203], v13 offset:0
    s_waitcnt lgkmcnt(9)
    s_nop 0
    v_mfma_f32_16x16x32_bf16 v[72:75], v[164:167], v[184:187], 0
    ds_read_b64_tr_b16 v[160:161], v8 offset:12352
    v_mfma_f32_16x16x32_bf16 v[76:79], v[164:167], v[188:191], 0
    ds_read_b64_tr_b16 v[162:163], v8 offset:13120
    v_mfma_f32_16x16x32_bf16 v[88:91], v[164:167], v[192:195], 0
    ds_read_b128 v[204:207], v13 offset:2048
    v_mfma_f32_16x16x32_bf16 v[92:95], v[164:167], v[196:199], 0
    ds_read_b128 v[208:211], v13 offset:4096
    s_waitcnt lgkmcnt(11)
    v_mfma_f32_16x16x32_bf16 v[96:99], v[168:171], v[184:187], 0
    s_waitcnt lgkmcnt(5)
    s_mov_b64 exec, 1
    buffer_load_dword v252, s[8:11], 0 offen offset:0 lds
    s_mov_b64 exec, -1
    v_mfma_f32_16x16x32_bf16 v[100:103], v[168:171], v[188:191], 0
    ds_read_b64_tr_b16 v[164:165], v8 offset:18528
    v_mfma_f32_16x16x32_bf16 v[112:115], v[168:171], v[192:195], 0
    ds_read_b64_tr_b16 v[166:167], v8 offset:19296
    v_mfma_f32_16x16x32_bf16 v[116:119], v[168:171], v[196:199], 0
    ds_read_b128 v[212:215], v13 offset:6144
    v_mfma_f32_16x16x32_bf16 v[104:107], v[172:175], v[184:187], 0
    ds_read_b64_tr_b16 v[168:169], v9 offset:12352
    v_mfma_f32_16x16x32_bf16 v[108:111], v[172:175], v[188:191], 0
    ds_read_b64_tr_b16 v[170:171], v9 offset:13120
    v_mfma_f32_16x16x32_bf16 v[120:123], v[172:175], v[192:195], 0
    v_lshrrev_b32_e64 v17, 5, v1
    v_lshl_add_u32 v16, v17, 3, v16
    v_mfma_f32_16x16x32_bf16 v[124:127], v[172:175], v[196:199], 0
    s_mul_i32 s33, s57, 48
    s_add_u32 s33, s33, 153920
    v_add_u32 v250, 32, v250
    v_mfma_f32_16x16x32_bf16 v[128:131], v[176:179], v[184:187], 0
    ds_read_b64_tr_b16 v[172:173], v9 offset:18528
    v_mfma_f32_16x16x32_bf16 v[132:135], v[176:179], v[188:191], 0
    ds_read_b64_tr_b16 v[174:175], v9 offset:19296
    v_mfma_f32_16x16x32_bf16 v[144:147], v[176:179], v[192:195], 0
    ds_read_b32 v251, v250
    v_mfma_f32_16x16x32_bf16 v[148:151], v[176:179], v[196:199], 0
    v_add_u32 v17, s33, v16
    v_and_b32 v24, 15, v1
    v_mfma_f32_16x16x32_bf16 v[136:139], v[180:183], v[184:187], 0
    ds_read_b64_tr_b16 v[176:177], v8 offset:12416
    v_mfma_f32_16x16x32_bf16 v[140:143], v[180:183], v[188:191], 0
    ds_read_b64_tr_b16 v[178:179], v8 offset:13184
    v_mfma_f32_16x16x32_bf16 v[152:155], v[180:183], v[192:195], 0
    s_lshl_b32 s33, s58, 9
    s_add_u32 s33, s33, 158016
    v_mfma_f32_16x16x32_bf16 v[156:159], v[180:183], v[196:199], 0
    s_cmp_lt_u32 s3, 2
    s_cbranch_scc1 L_ls_2
    s_nop 0
    buffer_store_dwordx4 v[48:51], v241, s[24:27], s66 offen offset:0 sc1
    buffer_store_dwordx4 v[52:55], v241, s[24:27], s66 offen offset:1024 sc1
    buffer_store_dwordx4 v[56:59], v241, s[24:27], s66 offen offset:2048 sc1
    buffer_store_dwordx4 v[60:63], v241, s[24:27], s66 offen offset:3072 sc1
    buffer_store_dwordx2 v[232:233], v234, s[24:27], s70 offen sc1
    s_mov_b64 exec, s[68:69]
    buffer_store_dwordx4 v[236:239], v240, s[24:27], s67 offen sc1
    s_mov_b64 exec, 1
    buffer_load_dword v252, s[8:11], 0 offen offset:960 lds
    s_mov_b64 exec, -1
L_ls_2:
    ds_read_b64_tr_b16 v[180:181], v8 offset:18592
    ds_read_b64_tr_b16 v[182:183], v8 offset:19360
    s_waitcnt lgkmcnt(4)
    v_mfma_f32_16x16x32_bf16 v[64:67], v[160:163], v[200:203], v[64:67]
    v_cmp_ne_u32_e64 vcc, 0, v251
    v_mfma_f32_16x16x32_bf16 v[68:71], v[160:163], v[204:207], v[68:71]
    v_lshl_add_u32 v19, v24, 3, s33
    s_mov_b32 s33, 162940
    v_mfma_f32_16x16x32_bf16 v[80:83], v[160:163], v[208:211], v[80:83]
    s_getpc_b64 s[62:63]
    s_cbranch_vccnz L_stub
    v_mfma_f32_16x16x32_bf16 v[84:87], v[160:163], v[212:215], v[84:87]
    ds_read_b128 v[184:187], v12 offset:16384
    v_mfma_f32_16x16x32_bf16 v[72:75], v[164:167], v[200:203], v[72:75]
    ds_read_b64_tr_b16 v[160:161], v8 offset:24704
    v_mfma_f32_16x16x32_bf16 v[76:79], v[164:167], v[204:207], v[76:79]
    ds_read_b64_tr_b16 v[162:163], v8 offset:25472
    v_mfma_f32_16x16x32_bf16 v[88:91], v[164:167], v[208:211], v[88:91]
    ds_read_b128 v[188:191], v12 offset:18432
    v_mfma_f32_16x16x32_bf16 v[92:95], v[164:167], v[212:215], v[92:95]
    ds_read_b128 v[192:195], v12 offset:20480
    v_mfma_f32_16x16x32_bf16 v[96:99], v[168:171], v[200:203], v[96:99]
    s_waitcnt lgkmcnt(5)
    s_mov_b64 exec, 1
    buffer_load_dword v252, s[8:11], 0 offen offset:32 lds
    s_mov_b64 exec, -1
    s_nop 0
    v_mfma_f32_16x16x32_bf16 v[100:103], v[168:171], v[204:207], v[100:103]
    ds_read_b64_tr_b16 v[164:165], v8 offset:30880
    v_mfma_f32_16x16x32_bf16 v[112:115], v[168:171], v[208:211], v[112:115]
    ds_read_b64_tr_b16 v[166:167], v8 offset:31648
    v_mfma_f32_16x16x32_bf16 v[116:119], v[168:171], v[212:215], v[116:119]
    ds_read_b128 v[196:199], v12 offset:22528
    v_mfma_f32_16x16x32_bf16 v[104:107], v[172:175], v[200:203], v[104:107]
    ds_read_b64_tr_b16 v[168:169], v9 offset:24704
    v_mfma_f32_16x16x32_bf16 v[108:111], v[172:175], v[204:207], v[108:111]
    ds_read_b64_tr_b16 v[170:171], v9 offset:25472
    v_mfma_f32_16x16x32_bf16 v[120:123], v[172:175], v[208:211], v[120:123]
    v_mov_b32 v18, 162916
    v_writelane_b32 v18, s33, 0
    v_mfma_f32_16x16x32_bf16 v[124:127], v[172:175], v[212:215], v[124:127]
    s_lshl_b32 s33, s50, 1
    s_add_u32 s33, s33, s58
    v_add_u32_e64 v250, 32, v250
    v_mfma_f32_16x16x32_bf16 v[128:131], v[176:179], v[200:203], v[128:131]
    ds_read_b64_tr_b16 v[172:173], v9 offset:30880
    v_mfma_f32_16x16x32_bf16 v[132:135], v[176:179], v[204:207], v[132:135]
    ds_read_b64_tr_b16 v[174:175], v9 offset:31648
    v_mfma_f32_16x16x32_bf16 v[144:147], v[176:179], v[208:211], v[144:147]
    ds_read_b32 v251, v250
    v_mfma_f32_16x16x32_bf16 v[148:151], v[176:179], v[212:215], v[148:151]
    v_lshlrev_b32 v37, 4, v1
    s_mul_i32 s32, s33, 37
    v_mfma_f32_16x16x32_bf16 v[136:139], v[180:183], v[200:203], v[136:139]
    ds_read_b64_tr_b16 v[176:177], v8 offset:24768
    v_mfma_f32_16x16x32_bf16 v[140:143], v[180:183], v[204:207], v[140:143]
    ds_read_b64_tr_b16 v[178:179], v8 offset:25536
    v_mfma_f32_16x16x32_bf16 v[152:155], v[180:183], v[208:211], v[152:155]
    s_lshr_b32 s32, s32, 8
    s_mul_i32 s32, s32, 7
    v_mfma_f32_16x16x32_bf16 v[156:159], v[180:183], v[212:215], v[156:159]
    s_sub_u32 s32, s33, s32
    s_add_u32 s32, s32, 4
    ds_read_b64_tr_b16 v[180:181], v8 offset:30944
    ds_read_b64_tr_b16 v[182:183], v8 offset:31712
    s_waitcnt lgkmcnt(4)
    v_mfma_f32_16x16x32_bf16 v[64:67], v[160:163], v[184:187], v[64:67]
    v_cmp_ne_u32 vcc, 0, v251
    v_mfma_f32_16x16x32_bf16 v[68:71], v[160:163], v[188:191], v[68:71]
    s_and_b32 s32, s32, 7
    s_lshl_b32 s32, s32, 7
    v_mfma_f32_16x16x32_bf16 v[80:83], v[160:163], v[192:195], v[80:83]
    s_getpc_b64 s[62:63]
    s_cbranch_vccnz L_stub
    v_mfma_f32_16x16x32_bf16 v[84:87], v[160:163], v[196:199], v[84:87]
    ds_read_b128 v[200:203], v13 offset:16384
    v_mfma_f32_16x16x32_bf16 v[72:75], v[164:167], v[184:187], v[72:75]
    ds_read_b64_tr_b16 v[160:161], v8 offset:37056
    v_mfma_f32_16x16x32_bf16 v[76:79], v[164:167], v[188:191], v[76:79]
    ds_read_b64_tr_b16 v[162:163], v8 offset:37824
    v_mfma_f32_16x16x32_bf16 v[88:91], v[164:167], v[192:195], v[88:91]
    ds_read_b128 v[204:207], v13 offset:18432
    v_mfma_f32_16x16x32_bf16 v[92:95], v[164:167], v[196:199], v[92:95]
    ds_read_b128 v[208:211], v13 offset:20480
    v_mfma_f32_16x16x32_bf16 v[96:99], v[168:171], v[184:187], v[96:99]
    s_waitcnt lgkmcnt(5)
    s_mov_b64 exec, 1
    buffer_load_dword v252, s[8:11], 0 offen offset:64 lds
    s_mov_b64 exec, -1
    s_nop 0
    v_mfma_f32_16x16x32_bf16 v[100:103], v[168:171], v[188:191], v[100:103]
    ds_read_b64_tr_b16 v[164:165], v8 offset:43232
    v_mfma_f32_16x16x32_bf16 v[112:115], v[168:171], v[192:195], v[112:115]
    ds_read_b64_tr_b16 v[166:167], v8 offset:44000
    v_mfma_f32_16x16x32_bf16 v[116:119], v[168:171], v[196:199], v[116:119]
    ds_read_b128 v[212:215], v13 offset:22528
    v_mfma_f32_16x16x32_bf16 v[104:107], v[172:175], v[184:187], v[104:107]
    ds_read_b64_tr_b16 v[168:169], v9 offset:37056
    v_mfma_f32_16x16x32_bf16 v[108:111], v[172:175], v[188:191], v[108:111]
    ds_read_b64_tr_b16 v[170:171], v9 offset:37824
    v_mfma_f32_16x16x32_bf16 v[120:123], v[172:175], v[192:195], v[120:123]
    s_add_u32 s32, s32, 20971136
    v_lshrrev_b32_e64 v42, 3, v1
    v_mfma_f32_16x16x32_bf16 v[124:127], v[172:175], v[196:199], v[124:127]
    v_cmp_eq_u32 s[34:35], 3, v42
    v_add_u32 v42, s32, v37
    v_add_u32 v250, 32, v250
    v_mfma_f32_16x16x32_bf16 v[128:131], v[176:179], v[184:187], v[128:131]
    ds_read_b64_tr_b16 v[172:173], v9 offset:43232
    v_mfma_f32_16x16x32_bf16 v[132:135], v[176:179], v[188:191], v[132:135]
    ds_read_b64_tr_b16 v[174:175], v9 offset:44000
    v_mfma_f32_16x16x32_bf16 v[144:147], v[176:179], v[192:195], v[144:147]
    ds_read_b32 v251, v250
    v_mfma_f32_16x16x32_bf16 v[148:151], v[176:179], v[196:199], v[148:151]
    s_nop 0
    s_nop 0
    v_cndmask_b32 v37, v37, v42, s[34:35]
    v_mfma_f32_16x16x32_bf16 v[136:139], v[180:183], v[184:187], v[136:139]
    ds_read_b64_tr_b16 v[176:177], v8 offset:37120
    v_mfma_f32_16x16x32_bf16 v[140:143], v[180:183], v[188:191], v[140:143]
    ds_read_b64_tr_b16 v[178:179], v8 offset:37888
    v_mfma_f32_16x16x32_bf16 v[152:155], v[180:183], v[192:195], v[152:155]
    s_lshl_b32 s32, s50, 2
    s_lshl_b32 s33, s58, 1
    v_mfma_f32_16x16x32_bf16 v[156:159], v[180:183], v[196:199], v[156:159]
    s_add_u32 s32, s32, s33
    s_nop 0
    s_mul_i32 s32, s32, 86
    ds_read_b64_tr_b16 v[180:181], v8 offset:43296
    ds_read_b64_tr_b16 v[182:183], v8 offset:44064
    s_waitcnt lgkmcnt(4)
    v_mfma_f32_16x16x32_bf16 v[64:67], v[160:163], v[200:203], v[64:67]
    v_cmp_ne_u32 vcc, 0, v251
    v_mfma_f32_16x16x32_bf16 v[68:71], v[160:163], v[204:207], v[68:71]
    s_lshl_b32 s36, s51, 1
    s_add_u32 s36, s36, s57
    v_mfma_f32_16x16x32_bf16 v[80:83], v[160:163], v[208:211], v[80:83]
    s_getpc_b64 s[62:63]
    s_cbranch_vccnz L_stub
    v_mfma_f32_16x16x32_bf16 v[84:87], v[160:163], v[212:215], v[84:87]
    ds_read_b128 v[184:187], v12 offset:32768
    v_mfma_f32_16x16x32_bf16 v[72:75], v[164:167], v[200:203], v[72:75]
    ds_read_b64_tr_b16 v[160:161], v8 offset:49408
    v_mfma_f32_16x16x32_bf16 v[76:79], v[164:167], v[204:207], v[76:79]
    ds_read_b64_tr_b16 v[162:163], v8 offset:50176
    v_mfma_f32_16x16x32_bf16 v[88:91], v[164:167], v[208:211], v[88:91]
    ds_read_b128 v[188:191], v12 offset:34816
    v_mfma_f32_16x16x32_bf16 v[92:95], v[164:167], v[212:215], v[92:95]
    ds_read_b128 v[192:195], v12 offset:36864
    v_mfma_f32_16x16x32_bf16 v[96:99], v[168:171], v[200:203], v[96:99]
    s_waitcnt lgkmcnt(5)
    s_mov_b64 exec, 1
    buffer_load_dword v252, s[8:11], 0 offen offset:96 lds
    s_mov_b64 exec, -1
    s_nop 0
    v_mfma_f32_16x16x32_bf16 v[100:103], v[168:171], v[204:207], v[100:103]
    ds_read_b64_tr_b16 v[164:165], v8 offset:55584
    v_mfma_f32_16x16x32_bf16 v[112:115], v[168:171], v[208:211], v[112:115]
    ds_read_b64_tr_b16 v[166:167], v8 offset:56352
    v_mfma_f32_16x16x32_bf16 v[116:119], v[168:171], v[212:215], v[116:119]
    ds_read_b128 v[196:199], v12 offset:38912
    v_mfma_f32_16x16x32_bf16 v[104:107], v[172:175], v[200:203], v[104:107]
    ds_read_b64_tr_b16 v[168:169], v9 offset:49408
    v_mfma_f32_16x16x32_bf16 v[108:111], v[172:175], v[204:207], v[108:111]
    ds_read_b64_tr_b16 v[170:171], v9 offset:50176
    v_mfma_f32_16x16x32_bf16 v[120:123], v[172:175], v[208:211], v[120:123]
    s_lshl_b32 s37, s50, 1
    s_add_u32 s37, s37, s58
    v_mfma_f32_16x16x32_bf16 v[124:127], v[172:175], v[212:215], v[124:127]
    s_lshl_b32 s37, s37, 6
    s_add_u32 s37, s37, s36
    v_add_u32_e64 v250, 32, v250
    v_mfma_f32_16x16x32_bf16 v[128:131], v[176:179], v[200:203], v[128:131]
    ds_read_b64_tr_b16 v[172:173], v9 offset:55584
    v_mfma_f32_16x16x32_bf16 v[132:135], v[176:179], v[204:207], v[132:135]
    ds_read_b64_tr_b16 v[174:175], v9 offset:56352
    v_mfma_f32_16x16x32_bf16 v[144:147], v[176:179], v[208:211], v[144:147]
    ds_read_b32 v251, v250
    v_mfma_f32_16x16x32_bf16 v[148:151], v[176:179], v[212:215], v[148:151]
    s_cmp_gt_u32 s36, 14
    s_cselect_b32 s33, 18, 0
    s_add_u32 s37, s37, s33
    s_nop 0
    v_mfma_f32_16x16x32_bf16 v[136:139], v[180:183], v[200:203], v[136:139]
    ds_read_b64_tr_b16 v[176:177], v8 offset:49472
    v_mfma_f32_16x16x32_bf16 v[140:143], v[180:183], v[204:207], v[140:143]
    ds_read_b64_tr_b16 v[178:179], v8 offset:50240
    v_mfma_f32_16x16x32_bf16 v[152:155], v[180:183], v[208:211], v[152:155]
    s_lshl_b32 s37, s37, 3
    s_nop 0
    s_add_u32 s37, s37, 16384
    v_mfma_f32_16x16x32_bf16 v[156:159], v[180:183], v[212:215], v[156:159]
    v_mov_b32 v36, 163008
    s_mul_i32 s36, s36, 3
    ds_read_b64_tr_b16 v[180:181], v8 offset:55648
    ds_read_b64_tr_b16 v[182:183], v8 offset:56416
    s_waitcnt lgkmcnt(4)
    v_mfma_f32_16x16x32_bf16 v[64:67], v[160:163], v[184:187], v[64:67]
    v_cmp_ne_u32_e64 vcc, 0, v251
    v_mfma_f32_16x16x32_bf16 v[68:71], v[160:163], v[188:191], v[68:71]
    s_add_u32 s32, s32, s36
    s_lshl_b32 s32, s32, 10
    v_mfma_f32_16x16x32_bf16 v[80:83], v[160:163], v[192:195], v[80:83]
    s_getpc_b64 s[62:63]
    s_cbranch_vccnz L_stub
    v_mfma_f32_16x16x32_bf16 v[84:87], v[160:163], v[196:199], v[84:87]
    ds_read_b128 v[200:203], v13 offset:32768
    v_mfma_f32_16x16x32_bf16 v[72:75], v[164:167], v[184:187], v[72:75]
    ds_read_b64_tr_b16 v[160:161], v10 offset:0
    v_mfma_f32_16x16x32_bf16 v[76:79], v[164:167], v[188:191], v[76:79]
    ds_read_b64_tr_b16 v[162:163], v10 offset:768
    v_mfma_f32_16x16x32_bf16 v[88:91], v[164:167], v[192:195], v[88:91]
    ds_read_b128 v[204:207], v13 offset:34816
    v_mfma_f32_16x16x32_bf16 v[92:95], v[164:167], v[196:199], v[92:95]
    ds_read_b128 v[208:211], v13 offset:36864
    v_mfma_f32_16x16x32_bf16 v[96:99], v[168:171], v[184:187], v[96:99]
    s_waitcnt lgkmcnt(5)
    s_mov_b64 exec, 1
    buffer_load_dword v252, s[8:11], 0 offen offset:128 lds
    s_mov_b64 exec, -1
    s_nop 0
    v_mfma_f32_16x16x32_bf16 v[100:103], v[168:171], v[188:191], v[100:103]
    ds_read_b64_tr_b16 v[164:165], v10 offset:6176
    v_mfma_f32_16x16x32_bf16 v[112:115], v[168:171], v[192:195], v[112:115]
    ds_read_b64_tr_b16 v[166:167], v10 offset:6944
    v_mfma_f32_16x16x32_bf16 v[116:119], v[168:171], v[196:199], v[116:119]
    ds_read_b128 v[212:215], v13 offset:38912
    v_mfma_f32_16x16x32_bf16 v[104:107], v[172:175], v[184:187], v[104:107]
    ds_read_b64_tr_b16 v[168:169], v11 offset:0
    v_mfma_f32_16x16x32_bf16 v[108:111], v[172:175], v[188:191], v[108:111]
    ds_read_b64_tr_b16 v[170:171], v11 offset:768
    v_mfma_f32_16x16x32_bf16 v[120:123], v[172:175], v[192:195], v[120:123]
    s_add_u32 s34, s32, 4194304
    s_add_u32 s35, s34, 88064
    v_mfma_f32_16x16x32_bf16 v[124:127], v[172:175], v[196:199], v[124:127]
    v_mov_b32 v26, 1.0
    s_lshr_b32 s32, s3, 1
    v_add_u32_e64 v250, 32, v250
    v_mfma_f32_16x16x32_bf16 v[128:131], v[176:179], v[184:187], v[128:131]
    ds_read_b64_tr_b16 v[172:173], v11 offset:6176
    v_mfma_f32_16x16x32_bf16 v[132:135], v[176:179], v[188:191], v[132:135]
    ds_read_b64_tr_b16 v[174:175], v11 offset:6944
    v_mfma_f32_16x16x32_bf16 v[144:147], v[176:179], v[192:195], v[144:147]
    ds_read_b32 v251, v250
    v_mfma_f32_16x16x32_bf16 v[148:151], v[176:179], v[196:199], v[148:151]
    s_lshl_b32 s33, s55, 2
    s_add_u32 s32, s32, s33
    v_mfma_f32_16x16x32_bf16 v[136:139], v[180:183], v[184:187], v[136:139]
    ds_read_b64_tr_b16 v[176:177], v10 offset:64
    v_mfma_f32_16x16x32_bf16 v[140:143], v[180:183], v[188:191], v[140:143]
    ds_read_b64_tr_b16 v[178:179], v10 offset:832
    v_mfma_f32_16x16x32_bf16 v[152:155], v[180:183], v[192:195], v[152:155]
    s_mul_i32 s38, s32, 16640
    s_add_u32 s38, s38, 1056772
    v_mfma_f32_16x16x32_bf16 v[156:159], v[180:183], v[196:199], v[156:159]
    s_lshl_b32 s33, s56, 1
    s_add_u32 s33, s33, s57
    ds_read_b64_tr_b16 v[180:181], v10 offset:6240
    ds_read_b64_tr_b16 v[182:183], v10 offset:7008
    s_waitcnt lgkmcnt(4)
    v_mfma_f32_16x16x32_bf16 v[64:67], v[160:163], v[200:203], v[64:67]
    v_cmp_ne_u32 vcc, 0, v251
    v_mfma_f32_16x16x32_bf16 v[68:71], v[160:163], v[204:207], v[68:71]
    s_lshl_b32 s33, s33, 6
    s_lshl_b32 s32, s32, 14
    v_mfma_f32_16x16x32_bf16 v[80:83], v[160:163], v[208:211], v[80:83]
    s_getpc_b64 s[62:63]
    s_cbranch_vccnz L_stub
    v_mfma_f32_16x16x32_bf16 v[84:87], v[160:163], v[212:215], v[84:87]
    ds_read_b128 v[184:187], v12 offset:49152
    v_mfma_f32_16x16x32_bf16 v[72:75], v[164:167], v[200:203], v[72:75]
    ds_read_b64_tr_b16 v[160:161], v10 offset:12352
    v_mfma_f32_16x16x32_bf16 v[76:79], v[164:167], v[204:207], v[76:79]
    ds_read_b64_tr_b16 v[162:163], v10 offset:13120
    v_mfma_f32_16x16x32_bf16 v[88:91], v[164:167], v[208:211], v[88:91]
    ds_read_b128 v[188:191], v12 offset:51200
    v_mfma_f32_16x16x32_bf16 v[92:95], v[164:167], v[212:215], v[92:95]
    ds_read_b128 v[192:195], v12 offset:53248
    v_mfma_f32_16x16x32_bf16 v[96:99], v[168:171], v[200:203], v[96:99]
    s_waitcnt lgkmcnt(5)
    s_mov_b64 exec, 1
    buffer_load_dword v252, s[8:11], 0 offen offset:160 lds
    s_mov_b64 exec, -1
    s_nop 0
    v_mfma_f32_16x16x32_bf16 v[100:103], v[168:171], v[204:207], v[100:103]
    ds_read_b64_tr_b16 v[164:165], v10 offset:18528
    v_mfma_f32_16x16x32_bf16 v[112:115], v[168:171], v[208:211], v[112:115]
    ds_read_b64_tr_b16 v[166:167], v10 offset:19296
    v_mfma_f32_16x16x32_bf16 v[116:119], v[168:171], v[212:215], v[116:119]
    ds_read_b128 v[196:199], v12 offset:55296
    v_mfma_f32_16x16x32_bf16 v[104:107], v[172:175], v[200:203], v[104:107]
    ds_read_b64_tr_b16 v[168:169], v11 offset:12352
    v_mfma_f32_16x16x32_bf16 v[108:111], v[172:175], v[204:207], v[108:111]
    ds_read_b64_tr_b16 v[170:171], v11 offset:13120
    v_mfma_f32_16x16x32_bf16 v[120:123], v[172:175], v[208:211], v[120:123]
    s_add_u32 s33, s33, s32
    v_and_b32 v42, 15, v1
    v_mfma_f32_16x16x32_bf16 v[124:127], v[172:175], v[212:215], v[124:127]
    v_lshlrev_b32 v42, 10, v42
    v_and_b32 v43, 48, v1
    v_add_u32_e64 v250, 32, v250
    v_mfma_f32_16x16x32_bf16 v[128:131], v[176:179], v[200:203], v[128:131]
    ds_read_b64_tr_b16 v[172:173], v11 offset:18528
    v_mfma_f32_16x16x32_bf16 v[132:135], v[176:179], v[204:207], v[132:135]
    ds_read_b64_tr_b16 v[174:175], v11 offset:19296
    v_mfma_f32_16x16x32_bf16 v[144:147], v[176:179], v[208:211], v[144:147]
    ds_read_b32 v251, v250
    v_mfma_f32_16x16x32_bf16 v[148:151], v[176:179], v[212:215], v[148:151]
    v_add3_u32 v249, v42, v43, s33
    v_bfe_u32 v42, v1, 3, 1
    v_mfma_f32_16x16x32_bf16 v[136:139], v[180:183], v[200:203], v[136:139]
    ds_read_b64_tr_b16 v[176:177], v10 offset:12416
    v_mfma_f32_16x16x32_bf16 v[140:143], v[180:183], v[204:207], v[140:143]
    ds_read_b64_tr_b16 v[178:179], v10 offset:13184
    v_mfma_f32_16x16x32_bf16 v[152:155], v[180:183], v[208:211], v[152:155]
    v_mul_u32_u24 v42, 8320, v42
    v_and_b32_e64 v43, 7, v1
    v_mfma_f32_16x16x32_bf16 v[156:159], v[180:183], v[212:215], v[156:159]
    v_lshl_add_u32 v3, v43, 3, v42
    v_and_b32_e64 v2, 3, v1
    ds_read_b64_tr_b16 v[180:181], v10 offset:18592
    ds_read_b64_tr_b16 v[182:183], v10 offset:19360
    s_waitcnt lgkmcnt(4)
    v_mfma_f32_16x16x32_bf16 v[64:67], v[160:163], v[184:187], v[64:67]
    v_cmp_ne_u32 vcc, 0, v251
    v_mfma_f32_16x16x32_bf16 v[68:71], v[160:163], v[188:191], v[68:71]
    v_lshlrev_b32_e64 v2, 2, v2
    v_add_u32 v2, 162608, v2
    v_mfma_f32_16x16x32_bf16 v[80:83], v[160:163], v[192:195], v[80:83]
    s_getpc_b64 s[62:63]
    s_cbranch_vccnz L_stub
    v_mfma_f32_16x16x32_bf16 v[84:87], v[160:163], v[196:199], v[84:87]
    ds_read_b128 v[200:203], v13 offset:49152
    v_mfma_f32_16x16x32_bf16 v[72:75], v[164:167], v[184:187], v[72:75]
    ds_read_b64_tr_b16 v[160:161], v8 offset:0
    v_mfma_f32_16x16x32_bf16 v[76:79], v[164:167], v[188:191], v[76:79]
    ds_read_b64_tr_b16 v[162:163], v8 offset:768
    v_mfma_f32_16x16x32_bf16 v[88:91], v[164:167], v[192:195], v[88:91]
    ds_read_b128 v[204:207], v13 offset:51200
    v_mfma_f32_16x16x32_bf16 v[92:95], v[164:167], v[196:199], v[92:95]
    ds_read_b128 v[208:211], v13 offset:53248
    v_mfma_f32_16x16x32_bf16 v[96:99], v[168:171], v[184:187], v[96:99]
    s_waitcnt lgkmcnt(5)
    s_mov_b64 exec, 1
    buffer_load_dword v252, s[8:11], 0 offen offset:192 lds
    s_mov_b64 exec, -1
    s_nop 0
    v_mfma_f32_16x16x32_bf16 v[100:103], v[168:171], v[188:191], v[100:103]
    ds_read_b64_tr_b16 v[164:165], v8 offset:6176
    v_mfma_f32_16x16x32_bf16 v[112:115], v[168:171], v[192:195], v[112:115]
    ds_read_b64_tr_b16 v[166:167], v8 offset:6944
    v_mfma_f32_16x16x32_bf16 v[116:119], v[168:171], v[196:199], v[116:119]
    ds_read_b128 v[212:215], v13 offset:55296
    v_mfma_f32_16x16x32_bf16 v[104:107], v[172:175], v[184:187], v[104:107]
    ds_read_b64_tr_b16 v[168:169], v9 offset:0
    v_mfma_f32_16x16x32_bf16 v[108:111], v[172:175], v[188:191], v[108:111]
    ds_read_b64_tr_b16 v[170:171], v9 offset:768
    v_mfma_f32_16x16x32_bf16 v[120:123], v[172:175], v[192:195], v[120:123]
    v_lshlrev_b32 v47, 4, v1
    s_mul_i32 s32, s55, 37
    v_mfma_f32_16x16x32_bf16 v[124:127], v[172:175], v[196:199], v[124:127]
    s_lshr_b32 s32, s32, 8
    s_mul_i32 s32, s32, 7
    v_add_u32_e64 v250, 32, v250
    v_mfma_f32_16x16x32_bf16 v[128:131], v[176:179], v[184:187], v[128:131]
    ds_read_b64_tr_b16 v[172:173], v9 offset:6176
    v_mfma_f32_16x16x32_bf16 v[132:135], v[176:179], v[188:191], v[132:135]
    ds_read_b64_tr_b16 v[174:175], v9 offset:6944
    v_mfma_f32_16x16x32_bf16 v[144:147], v[176:179], v[192:195], v[144:147]
    ds_read_b32 v251, v250
    v_mfma_f32_16x16x32_bf16 v[148:151], v[176:179], v[196:199], v[148:151]
    s_sub_u32 s32, s55, s32
    s_add_u32 s32, s32, 4
    v_mfma_f32_16x16x32_bf16 v[136:139], v[180:183], v[184:187], v[136:139]
    ds_read_b64_tr_b16 v[176:177], v8 offset:64
    v_mfma_f32_16x16x32_bf16 v[140:143], v[180:183], v[188:191], v[140:143]
    ds_read_b64_tr_b16 v[178:179], v8 offset:832
    v_mfma_f32_16x16x32_bf16 v[152:155], v[180:183], v[192:195], v[152:155]
    s_and_b32 s32, s32, 7
    s_lshl_b32 s32, s32, 7
    v_mfma_f32_16x16x32_bf16 v[156:159], v[180:183], v[196:199], v[156:159]
    s_add_u32 s32, s32, 20971136
    v_lshrrev_b32_e64 v42, 3, v1
    ds_read_b64_tr_b16 v[180:181], v8 offset:6240
    ds_read_b64_tr_b16 v[182:183], v8 offset:7008
    s_waitcnt lgkmcnt(4)
    v_mfma_f32_16x16x32_bf16 v[64:67], v[160:163], v[200:203], v[64:67]
    v_cmp_ne_u32 vcc, 0, v251
    v_mfma_f32_16x16x32_bf16 v[68:71], v[160:163], v[204:207], v[68:71]
    v_cmp_eq_u32 s[6:7], 3, v42
    v_add_u32_e64 v42, s32, v47
    v_mfma_f32_16x16x32_bf16 v[80:83], v[160:163], v[208:211], v[80:83]
    s_getpc_b64 s[62:63]
    s_cbranch_vccnz L_stub
    v_mfma_f32_16x16x32_bf16 v[84:87], v[160:163], v[212:215], v[84:87]
    ds_read_b128 v[184:187], v12 offset:0
    v_mfma_f32_16x16x32_bf16 v[72:75], v[164:167], v[200:203], v[72:75]
    ds_read_b64_tr_b16 v[160:161], v8 offset:12352
    v_mfma_f32_16x16x32_bf16 v[76:79], v[164:167], v[204:207], v[76:79]
    ds_read_b64_tr_b16 v[162:163], v8 offset:13120
    v_mfma_f32_16x16x32_bf16 v[88:91], v[164:167], v[208:211], v[88:91]
    ds_read_b128 v[188:191], v12 offset:2048
    v_mfma_f32_16x16x32_bf16 v[92:95], v[164:167], v[212:215], v[92:95]
    ds_read_b128 v[192:195], v12 offset:4096
    v_mfma_f32_16x16x32_bf16 v[96:99], v[168:171], v[200:203], v[96:99]
    s_waitcnt lgkmcnt(5)
    s_mov_b64 exec, 1
    buffer_load_dword v252, s[8:11], 0 offen offset:224 lds
    s_mov_b64 exec, -1
    s_nop 0
    v_mfma_f32_16x16x32_bf16 v[100:103], v[168:171], v[204:207], v[100:103]
    ds_read_b64_tr_b16 v[164:165], v8 offset:18528
    v_mfma_f32_16x16x32_bf16 v[112:115], v[168:171], v[208:211], v[112:115]
    ds_read_b64_tr_b16 v[166:167], v8 offset:19296
    v_mfma_f32_16x16x32_bf16 v[116:119], v[168:171], v[212:215], v[116:119]
    ds_read_b128 v[196:199], v12 offset:6144
    v_mfma_f32_16x16x32_bf16 v[104:107], v[172:175], v[200:203], v[104:107]
    ds_read_b64_tr_b16 v[168:169], v9 offset:12352
    v_mfma_f32_16x16x32_bf16 v[108:111], v[172:175], v[204:207], v[108:111]
    ds_read_b64_tr_b16 v[170:171], v9 offset:13120
    v_mfma_f32_16x16x32_bf16 v[120:123], v[172:175], v[208:211], v[120:123]
    s_nop 0
    s_nop 0
    v_cndmask_b32 v47, v47, v42, s[6:7]
    v_mfma_f32_16x16x32_bf16 v[124:127], v[172:175], v[212:215], v[124:127]
    v_bfe_u32 v42, v1, 2, 2
    v_lshrrev_b32 v43, 5, v1
    v_add_u32 v250, 32, v250
    v_mfma_f32_16x16x32_bf16 v[128:131], v[176:179], v[200:203], v[128:131]
    ds_read_b64_tr_b16 v[172:173], v9 offset:18528
    v_mfma_f32_16x16x32_bf16 v[132:135], v[176:179], v[204:207], v[132:135]
    ds_read_b64_tr_b16 v[174:175], v9 offset:19296
    v_mfma_f32_16x16x32_bf16 v[144:147], v[176:179], v[208:211], v[144:147]
    ds_read_b32 v251, v250
    v_mfma_f32_16x16x32_bf16 v[148:151], v[176:179], v[212:215], v[148:151]
    v_lshl_add_u32 v43, v43, 3, v42
    v_lshlrev_b32_e64 v43, 7, v43
    v_mfma_f32_16x16x32_bf16 v[136:139], v[180:183], v[200:203], v[136:139]
    ds_read_b64_tr_b16 v[176:177], v8 offset:12416
    v_mfma_f32_16x16x32_bf16 v[140:143], v[180:183], v[204:207], v[140:143]
    ds_read_b64_tr_b16 v[178:179], v8 offset:13184
    v_mfma_f32_16x16x32_bf16 v[152:155], v[180:183], v[208:211], v[152:155]
    v_lshrrev_b32 v42, 1, v42
    v_lshlrev_b32 v42, 6, v42
    v_mfma_f32_16x16x32_bf16 v[156:159], v[180:183], v[212:215], v[156:159]
    v_bfe_u32 v44, v1, 4, 1
    v_lshlrev_b32_e64 v44, 5, v44
    ds_read_b64_tr_b16 v[180:181], v8 offset:18592
    ds_read_b64_tr_b16 v[182:183], v8 offset:19360
    s_waitcnt lgkmcnt(4)
    v_mfma_f32_16x16x32_bf16 v[64:67], v[160:163], v[184:187], v[64:67]
    v_cmp_ne_u32 vcc, 0, v251
    v_mfma_f32_16x16x32_bf16 v[68:71], v[160:163], v[188:191], v[68:71]
    v_and_b32_e64 v45, 3, v1
    v_lshl_add_u32 v44, v45, 3, v44
    v_mfma_f32_16x16x32_bf16 v[80:83], v[160:163], v[192:195], v[80:83]
    s_getpc_b64 s[62:63]
    s_cbranch_vccnz L_stub
    v_mfma_f32_16x16x32_bf16 v[84:87], v[160:163], v[196:199], v[84:87]
    ds_read_b128 v[200:203], v13 offset:0
    v_mfma_f32_16x16x32_bf16 v[72:75], v[164:167], v[184:187], v[72:75]
    ds_read_b64_tr_b16 v[160:161], v8 offset:24704
    v_mfma_f32_16x16x32_bf16 v[76:79], v[164:167], v[188:191], v[76:79]
    ds_read_b64_tr_b16 v[162:163], v8 offset:25472
    v_mfma_f32_16x16x32_bf16 v[88:91], v[164:167], v[192:195], v[88:91]
    ds_read_b128 v[204:207], v13 offset:2048
    v_mfma_f32_16x16x32_bf16 v[92:95], v[164:167], v[196:199], v[92:95]
    ds_read_b128 v[208:211], v13 offset:4096
    v_mfma_f32_16x16x32_bf16 v[96:99], v[168:171], v[184:187], v[96:99]
    s_waitcnt lgkmcnt(5)
    s_mov_b64 exec, 1
    buffer_load_dword v252, s[8:11], 0 offen offset:256 lds
    s_mov_b64 exec, -1
    s_nop 0
    v_mfma_f32_16x16x32_bf16 v[100:103], v[168:171], v[188:191], v[100:103]
    ds_read_b64_tr_b16 v[164:165], v8 offset:30880
    v_mfma_f32_16x16x32_bf16 v[112:115], v[168:171], v[192:195], v[112:115]
    ds_read_b64_tr_b16 v[166:167], v8 offset:31648
    v_mfma_f32_16x16x32_bf16 v[116:119], v[168:171], v[196:199], v[116:119]
    ds_read_b128 v[212:215], v13 offset:6144
    v_mfma_f32_16x16x32_bf16 v[104:107], v[172:175], v[184:187], v[104:107]
    ds_read_b64_tr_b16 v[168:169], v9 offset:24704
    v_mfma_f32_16x16x32_bf16 v[108:111], v[172:175], v[188:191], v[108:111]
    ds_read_b64_tr_b16 v[170:171], v9 offset:25472
    v_mfma_f32_16x16x32_bf16 v[120:123], v[172:175], v[192:195], v[120:123]
    v_add3_u32 v42, v42, v43, v44
    s_lshl_b32 s32, s58, 11
    v_mfma_f32_16x16x32_bf16 v[124:127], v[172:175], v[196:199], v[124:127]
    v_add_u32 v38, s32, v42
    v_xor_b32 v39, 64, v38
    v_add_u32 v250, 32, v250
    v_mfma_f32_16x16x32_bf16 v[128:131], v[176:179], v[184:187], v[128:131]
    ds_read_b64_tr_b16 v[172:173], v9 offset:30880
    v_mfma_f32_16x16x32_bf16 v[132:135], v[176:179], v[188:191], v[132:135]
    ds_read_b64_tr_b16 v[174:175], v9 offset:31648
    v_mfma_f32_16x16x32_bf16 v[144:147], v[176:179], v[192:195], v[144:147]
    ds_read_b32 v251, v250
    v_mfma_f32_16x16x32_bf16 v[148:151], v[176:179], v[196:199], v[148:151]
    v_add_u32 v40, 0x10000, v38
    v_add_u32 v41, 0x10000, v39
    v_mfma_f32_16x16x32_bf16 v[136:139], v[180:183], v[184:187], v[136:139]
    ds_read_b64_tr_b16 v[176:177], v8 offset:24768
    v_mfma_f32_16x16x32_bf16 v[140:143], v[180:183], v[188:191], v[140:143]
    ds_read_b64_tr_b16 v[178:179], v8 offset:25536
    v_mfma_f32_16x16x32_bf16 v[152:155], v[180:183], v[192:195], v[152:155]
    s_lshl_b32 s32, s55, 1
    s_add_u32 s32, s32, s57
    v_mfma_f32_16x16x32_bf16 v[156:159], v[180:183], v[196:199], v[156:159]
    s_mul_i32 s32, s32, 86
    s_mul_i32 s33, s58, 43
    ds_read_b64_tr_b16 v[180:181], v8 offset:30944
    ds_read_b64_tr_b16 v[182:183], v8 offset:31712
    s_waitcnt lgkmcnt(4)
    v_mfma_f32_16x16x32_bf16 v[64:67], v[160:163], v[200:203], v[64:67]
    v_cmp_ne_u32_e64 vcc, 0, v251
    v_mfma_f32_16x16x32_bf16 v[68:71], v[160:163], v[204:207], v[68:71]
    s_add_u32 s32, s32, s33
    s_lshl_b32 s32, s32, 10
    v_mfma_f32_16x16x32_bf16 v[80:83], v[160:163], v[208:211], v[80:83]
    s_getpc_b64 s[62:63]
    s_cbranch_vccnz L_stub
    v_mfma_f32_16x16x32_bf16 v[84:87], v[160:163], v[212:215], v[84:87]
    ds_read_b128 v[184:187], v12 offset:16384
    v_mfma_f32_16x16x32_bf16 v[72:75], v[164:167], v[200:203], v[72:75]
    ds_read_b64_tr_b16 v[160:161], v8 offset:37056
    v_mfma_f32_16x16x32_bf16 v[76:79], v[164:167], v[204:207], v[76:79]
    ds_read_b64_tr_b16 v[162:163], v8 offset:37824
    v_mfma_f32_16x16x32_bf16 v[88:91], v[164:167], v[208:211], v[88:91]
    ds_read_b128 v[188:191], v12 offset:18432
    v_mfma_f32_16x16x32_bf16 v[92:95], v[164:167], v[212:215], v[92:95]
    ds_read_b128 v[192:195], v12 offset:20480
    v_mfma_f32_16x16x32_bf16 v[96:99], v[168:171], v[200:203], v[96:99]
    s_waitcnt lgkmcnt(5)
    s_mov_b64 exec, 1
    buffer_load_dword v252, s[8:11], 0 offen offset:288 lds
    s_mov_b64 exec, -1
    s_nop 0
    v_mfma_f32_16x16x32_bf16 v[100:103], v[168:171], v[204:207], v[100:103]
    ds_read_b64_tr_b16 v[164:165], v8 offset:43232
    v_mfma_f32_16x16x32_bf16 v[112:115], v[168:171], v[208:211], v[112:115]
    ds_read_b64_tr_b16 v[166:167], v8 offset:44000
    v_mfma_f32_16x16x32_bf16 v[116:119], v[168:171], v[212:215], v[116:119]
    ds_read_b128 v[196:199], v12 offset:22528
    v_mfma_f32_16x16x32_bf16 v[104:107], v[172:175], v[200:203], v[104:107]
    ds_read_b64_tr_b16 v[168:169], v9 offset:37056
    v_mfma_f32_16x16x32_bf16 v[108:111], v[172:175], v[204:207], v[108:111]
    ds_read_b64_tr_b16 v[170:171], v9 offset:37824
    v_mfma_f32_16x16x32_bf16 v[120:123], v[172:175], v[208:211], v[120:123]
    s_add_u32 s40, s32, 4194304
    v_lshrrev_b32_e64 v42, 3, v1
    v_mfma_f32_16x16x32_bf16 v[124:127], v[172:175], v[212:215], v[124:127]
    v_lshlrev_b32 v42, 10, v42
    v_lshrrev_b32 v43, 2, v1
    v_add_u32_e64 v250, 32, v250
    v_mfma_f32_16x16x32_bf16 v[128:131], v[176:179], v[200:203], v[128:131]
    ds_read_b64_tr_b16 v[172:173], v9 offset:43232
    v_mfma_f32_16x16x32_bf16 v[132:135], v[176:179], v[204:207], v[132:135]
    ds_read_b64_tr_b16 v[174:175], v9 offset:44000
    v_mfma_f32_16x16x32_bf16 v[144:147], v[176:179], v[208:211], v[144:147]
    ds_read_b32 v251, v250
    v_mfma_f32_16x16x32_bf16 v[148:151], v[176:179], v[212:215], v[148:151]
    v_and_b32 v43, 4, v43
    v_and_b32 v44, 7, v1
    v_mfma_f32_16x16x32_bf16 v[136:139], v[180:183], v[200:203], v[136:139]
    ds_read_b64_tr_b16 v[176:177], v8 offset:37120
    v_mfma_f32_16x16x32_bf16 v[140:143], v[180:183], v[204:207], v[140:143]
    ds_read_b64_tr_b16 v[178:179], v8 offset:37888
    v_mfma_f32_16x16x32_bf16 v[152:155], v[180:183], v[208:211], v[152:155]
    v_xor_b32_e64 v43, v43, v44
    v_lshl_add_u32 v46, v43, 4, v42
    v_mfma_f32_16x16x32_bf16 v[156:159], v[180:183], v[212:215], v[156:159]
    s_mul_i32 s44, s58, 704512
    s_lshl_b32 s32, s56, 7
    ds_read_b64_tr_b16 v[180:181], v8 offset:43296
    ds_read_b64_tr_b16 v[182:183], v8 offset:44064
    s_waitcnt lgkmcnt(4)
    v_mfma_f32_16x16x32_bf16 v[64:67], v[160:163], v[184:187], v[64:67]
    v_cmp_ne_u32_e64 vcc, 0, v251
    v_mfma_f32_16x16x32_bf16 v[68:71], v[160:163], v[188:191], v[68:71]
    s_add_u32 s44, s44, s32
    s_lshl_b32 s32, s57, 13
    v_mfma_f32_16x16x32_bf16 v[80:83], v[160:163], v[192:195], v[80:83]
    s_getpc_b64 s[62:63]
    s_cbranch_vccnz L_stub
    v_mfma_f32_16x16x32_bf16 v[84:87], v[160:163], v[196:199], v[84:87]
    ds_read_b128 v[200:203], v13 offset:16384
    v_mfma_f32_16x16x32_bf16 v[72:75], v[164:167], v[184:187], v[72:75]
    ds_read_b64_tr_b16 v[160:161], v8 offset:49408
    v_mfma_f32_16x16x32_bf16 v[76:79], v[164:167], v[188:191], v[76:79]
    ds_read_b64_tr_b16 v[162:163], v8 offset:50176
    v_mfma_f32_16x16x32_bf16 v[88:91], v[164:167], v[192:195], v[88:91]
    ds_read_b128 v[204:207], v13 offset:18432
    v_mfma_f32_16x16x32_bf16 v[92:95], v[164:167], v[196:199], v[92:95]
    ds_read_b128 v[208:211], v13 offset:20480
    v_mfma_f32_16x16x32_bf16 v[96:99], v[168:171], v[184:187], v[96:99]
    s_waitcnt lgkmcnt(5)
    s_mov_b64 exec, 1
    buffer_load_dword v252, s[8:11], 0 offen offset:320 lds
    s_mov_b64 exec, -1
    s_nop 0
    v_mfma_f32_16x16x32_bf16 v[100:103], v[168:171], v[188:191], v[100:103]
    ds_read_b64_tr_b16 v[164:165], v8 offset:55584
    v_mfma_f32_16x16x32_bf16 v[112:115], v[168:171], v[192:195], v[112:115]
    ds_read_b64_tr_b16 v[166:167], v8 offset:56352
    v_mfma_f32_16x16x32_bf16 v[116:119], v[168:171], v[196:199], v[116:119]
    ds_read_b128 v[212:215], v13 offset:22528
    v_mfma_f32_16x16x32_bf16 v[104:107], v[172:175], v[184:187], v[104:107]
    ds_read_b64_tr_b16 v[168:169], v9 offset:49408
    v_mfma_f32_16x16x32_bf16 v[108:111], v[172:175], v[188:191], v[108:111]
    ds_read_b64_tr_b16 v[170:171], v9 offset:50176
    v_mfma_f32_16x16x32_bf16 v[120:123], v[172:175], v[192:195], v[120:123]
    s_add_u32 s44, s44, s32
    s_add_u32 s44, s44, 245760
    v_mfma_f32_16x16x32_bf16 v[124:127], v[172:175], v[196:199], v[124:127]
    s_lshl_b32 s45, s58, 11
    s_lshl_b32 s32, s57, 10
    v_add_u32 v250, 32, v250
    v_mfma_f32_16x16x32_bf16 v[128:131], v[176:179], v[184:187], v[128:131]
    ds_read_b64_tr_b16 v[172:173], v9 offset:55584
    v_mfma_f32_16x16x32_bf16 v[132:135], v[176:179], v[188:191], v[132:135]
    ds_read_b64_tr_b16 v[174:175], v9 offset:56352
    v_mfma_f32_16x16x32_bf16 v[144:147], v[176:179], v[192:195], v[144:147]
    ds_read_b32 v251, v250
    v_mfma_f32_16x16x32_bf16 v[148:151], v[176:179], v[196:199], v[148:151]
    s_add_u32 s45, s45, s32
    s_lshl_b32 s32, s55, 1
    v_mfma_f32_16x16x32_bf16 v[136:139], v[180:183], v[184:187], v[136:139]
    ds_read_b64_tr_b16 v[176:177], v8 offset:49472
    v_mfma_f32_16x16x32_bf16 v[140:143], v[180:183], v[188:191], v[140:143]
    ds_read_b64_tr_b16 v[178:179], v8 offset:50240
    v_mfma_f32_16x16x32_bf16 v[152:155], v[180:183], v[192:195], v[152:155]
    s_add_u32 s32, s32, s58
    s_lshl_b32 s32, s32, 8
    v_mfma_f32_16x16x32_bf16 v[156:159], v[180:183], v[196:199], v[156:159]
    s_add_u32 s47, s32, 16384
    s_mov_b64 s[100:101], s[94:95]
    ds_read_b64_tr_b16 v[180:181], v8 offset:55648
    ds_read_b64_tr_b16 v[182:183], v8 offset:56416
    s_waitcnt lgkmcnt(4)
    v_mfma_f32_16x16x32_bf16 v[64:67], v[160:163], v[200:203], v[64:67]
    v_cmp_ne_u32_e64 vcc, 0, v251
    v_mfma_f32_16x16x32_bf16 v[68:71], v[160:163], v[204:207], v[68:71]
    v_mfma_f32_16x16x32_bf16 v[80:83], v[160:163], v[208:211], v[80:83]
    s_getpc_b64 s[62:63]
    s_cbranch_vccnz L_stub
    v_mfma_f32_16x16x32_bf16 v[84:87], v[160:163], v[212:215], v[84:87]
    ds_read_b128 v[184:187], v12 offset:32768
    v_mfma_f32_16x16x32_bf16 v[72:75], v[164:167], v[200:203], v[72:75]
    ds_read_b64_tr_b16 v[160:161], v10 offset:0
    v_mfma_f32_16x16x32_bf16 v[76:79], v[164:167], v[204:207], v[76:79]
    ds_read_b64_tr_b16 v[162:163], v10 offset:768
    v_mfma_f32_16x16x32_bf16 v[88:91], v[164:167], v[208:211], v[88:91]
    ds_read_b128 v[188:191], v12 offset:34816
    v_mfma_f32_16x16x32_bf16 v[92:95], v[164:167], v[212:215], v[92:95]
    ds_read_b128 v[192:195], v12 offset:36864
    v_mfma_f32_16x16x32_bf16 v[96:99], v[168:171], v[200:203], v[96:99]
    s_waitcnt lgkmcnt(5)
    s_mov_b64 exec, 1
    buffer_load_dword v252, s[8:11], 0 offen offset:352 lds
    s_mov_b64 exec, -1
    s_nop 0
    v_mfma_f32_16x16x32_bf16 v[100:103], v[168:171], v[204:207], v[100:103]
    ds_read_b64_tr_b16 v[164:165], v10 offset:6176
    v_mfma_f32_16x16x32_bf16 v[112:115], v[168:171], v[208:211], v[112:115]
    ds_read_b64_tr_b16 v[166:167], v10 offset:6944
    v_mfma_f32_16x16x32_bf16 v[116:119], v[168:171], v[212:215], v[116:119]
    ds_read_b128 v[196:199], v12 offset:38912
    v_mfma_f32_16x16x32_bf16 v[104:107], v[172:175], v[200:203], v[104:107]
    ds_read_b64_tr_b16 v[168:169], v11 offset:0
    v_mfma_f32_16x16x32_bf16 v[108:111], v[172:175], v[204:207], v[108:111]
    ds_read_b64_tr_b16 v[170:171], v11 offset:768
    v_mfma_f32_16x16x32_bf16 v[120:123], v[172:175], v[208:211], v[120:123]
    v_mfma_f32_16x16x32_bf16 v[124:127], v[172:175], v[212:215], v[124:127]
    v_add_u32_e64 v250, 32, v250
    v_mfma_f32_16x16x32_bf16 v[128:131], v[176:179], v[200:203], v[128:131]
    ds_read_b64_tr_b16 v[172:173], v11 offset:6176
    v_mfma_f32_16x16x32_bf16 v[132:135], v[176:179], v[204:207], v[132:135]
    ds_read_b64_tr_b16 v[174:175], v11 offset:6944
    v_mfma_f32_16x16x32_bf16 v[144:147], v[176:179], v[208:211], v[144:147]
    ds_read_b32 v251, v250
    v_mfma_f32_16x16x32_bf16 v[148:151], v[176:179], v[212:215], v[148:151]
    v_mfma_f32_16x16x32_bf16 v[136:139], v[180:183], v[200:203], v[136:139]
    ds_read_b64_tr_b16 v[176:177], v10 offset:64
    v_mfma_f32_16x16x32_bf16 v[140:143], v[180:183], v[204:207], v[140:143]
    ds_read_b64_tr_b16 v[178:179], v10 offset:832
    v_mfma_f32_16x16x32_bf16 v[152:155], v[180:183], v[208:211], v[152:155]
    v_mfma_f32_16x16x32_bf16 v[156:159], v[180:183], v[212:215], v[156:159]
    ds_read_b64_tr_b16 v[180:181], v10 offset:6240
    ds_read_b64_tr_b16 v[182:183], v10 offset:7008
    s_waitcnt lgkmcnt(4)
    v_mfma_f32_16x16x32_bf16 v[64:67], v[160:163], v[184:187], v[64:67]
    v_cmp_ne_u32 vcc, 0, v251
    v_mfma_f32_16x16x32_bf16 v[68:71], v[160:163], v[188:191], v[68:71]
    v_mfma_f32_16x16x32_bf16 v[80:83], v[160:163], v[192:195], v[80:83]
    s_getpc_b64 s[62:63]
    s_cbranch_vccnz L_stub
    v_mfma_f32_16x16x32_bf16 v[84:87], v[160:163], v[196:199], v[84:87]
    ds_read_b128 v[200:203], v13 offset:32768
    v_mfma_f32_16x16x32_bf16 v[72:75], v[164:167], v[184:187], v[72:75]
    ds_read_b64_tr_b16 v[160:161], v8 offset:0
    v_mfma_f32_16x16x32_bf16 v[76:79], v[164:167], v[188:191], v[76:79]
    ds_read_b64_tr_b16 v[162:163], v8 offset:768
    v_mfma_f32_16x16x32_bf16 v[88:91], v[164:167], v[192:195], v[88:91]
    ds_read_b128 v[204:207], v13 offset:34816
    v_mfma_f32_16x16x32_bf16 v[92:95], v[164:167], v[196:199], v[92:95]
    ds_read_b128 v[208:211], v13 offset:36864
    v_mfma_f32_16x16x32_bf16 v[96:99], v[168:171], v[184:187], v[96:99]
    s_waitcnt lgkmcnt(5)
    s_mov_b64 exec, 1
    buffer_load_dword v252, s[8:11], 0 offen offset:384 lds
    s_mov_b64 exec, -1
    s_nop 0
    v_mfma_f32_16x16x32_bf16 v[100:103], v[168:171], v[188:191], v[100:103]
    ds_read_b64_tr_b16 v[164:165], v8 offset:6176
    v_mfma_f32_16x16x32_bf16 v[112:115], v[168:171], v[192:195], v[112:115]
    ds_read_b64_tr_b16 v[166:167], v8 offset:6944
    v_mfma_f32_16x16x32_bf16 v[116:119], v[168:171], v[196:199], v[116:119]
    ds_read_b128 v[212:215], v13 offset:38912
    v_mfma_f32_16x16x32_bf16 v[104:107], v[172:175], v[184:187], v[104:107]
    ds_read_b64_tr_b16 v[168:169], v9 offset:0
    v_mfma_f32_16x16x32_bf16 v[108:111], v[172:175], v[188:191], v[108:111]
    ds_read_b64_tr_b16 v[170:171], v9 offset:768
    v_mfma_f32_16x16x32_bf16 v[120:123], v[172:175], v[192:195], v[120:123]
    v_mfma_f32_16x16x32_bf16 v[124:127], v[172:175], v[196:199], v[124:127]
    v_add_u32_e64 v250, 32, v250
    v_mfma_f32_16x16x32_bf16 v[128:131], v[176:179], v[184:187], v[128:131]
    ds_read_b64_tr_b16 v[172:173], v9 offset:6176
    v_mfma_f32_16x16x32_bf16 v[132:135], v[176:179], v[188:191], v[132:135]
    ds_read_b64_tr_b16 v[174:175], v9 offset:6944
    v_mfma_f32_16x16x32_bf16 v[144:147], v[176:179], v[192:195], v[144:147]
    ds_read_b32 v251, v250
    v_mfma_f32_16x16x32_bf16 v[148:151], v[176:179], v[196:199], v[148:151]
    v_mfma_f32_16x16x32_bf16 v[136:139], v[180:183], v[184:187], v[136:139]
    ds_read_b64_tr_b16 v[176:177], v8 offset:64
    v_mfma_f32_16x16x32_bf16 v[140:143], v[180:183], v[188:191], v[140:143]
    ds_read_b64_tr_b16 v[178:179], v8 offset:832
    v_mfma_f32_16x16x32_bf16 v[152:155], v[180:183], v[192:195], v[152:155]
    v_mfma_f32_16x16x32_bf16 v[156:159], v[180:183], v[196:199], v[156:159]
    ds_read_b64_tr_b16 v[180:181], v8 offset:6240
    ds_read_b64_tr_b16 v[182:183], v8 offset:7008
    s_waitcnt lgkmcnt(4)
    v_mfma_f32_16x16x32_bf16 v[64:67], v[160:163], v[200:203], v[64:67]
    v_cmp_ne_u32 vcc, 0, v251
    v_mfma_f32_16x16x32_bf16 v[68:71], v[160:163], v[204:207], v[68:71]
    v_mfma_f32_16x16x32_bf16 v[80:83], v[160:163], v[208:211], v[80:83]
    s_getpc_b64 s[62:63]
    s_cbranch_vccnz L_stub
    v_mfma_f32_16x16x32_bf16 v[84:87], v[160:163], v[212:215], v[84:87]
    ds_read_b128 v[184:187], v12 offset:49152
    v_mfma_f32_16x16x32_bf16 v[72:75], v[164:167], v[200:203], v[72:75]
    ds_read_b64_tr_b16 v[160:161], v8 offset:12352
    v_mfma_f32_16x16x32_bf16 v[76:79], v[164:167], v[204:207], v[76:79]
    ds_read_b64_tr_b16 v[162:163], v8 offset:13120
    v_mfma_f32_16x16x32_bf16 v[88:91], v[164:167], v[208:211], v[88:91]
    ds_read_b128 v[188:191], v12 offset:51200
    v_mfma_f32_16x16x32_bf16 v[92:95], v[164:167], v[212:215], v[92:95]
    ds_read_b128 v[192:195], v12 offset:53248
    v_mfma_f32_16x16x32_bf16 v[96:99], v[168:171], v[200:203], v[96:99]
    s_waitcnt lgkmcnt(5)
    s_mov_b64 exec, 1
    buffer_load_dword v252, s[8:11], 0 offen offset:416 lds
    s_mov_b64 exec, -1
    s_nop 0
    v_mfma_f32_16x16x32_bf16 v[100:103], v[168:171], v[204:207], v[100:103]
    ds_read_b64_tr_b16 v[164:165], v8 offset:18528
    v_mfma_f32_16x16x32_bf16 v[112:115], v[168:171], v[208:211], v[112:115]
    ds_read_b64_tr_b16 v[166:167], v8 offset:19296
    v_mfma_f32_16x16x32_bf16 v[116:119], v[168:171], v[212:215], v[116:119]
    ds_read_b128 v[196:199], v12 offset:55296
    v_mfma_f32_16x16x32_bf16 v[104:107], v[172:175], v[200:203], v[104:107]
    ds_read_b64_tr_b16 v[168:169], v9 offset:12352
    v_mfma_f32_16x16x32_bf16 v[108:111], v[172:175], v[204:207], v[108:111]
    ds_read_b64_tr_b16 v[170:171], v9 offset:13120
    v_mfma_f32_16x16x32_bf16 v[120:123], v[172:175], v[208:211], v[120:123]
    v_mfma_f32_16x16x32_bf16 v[124:127], v[172:175], v[212:215], v[124:127]
    v_add_u32_e64 v250, 32, v250
    v_mfma_f32_16x16x32_bf16 v[128:131], v[176:179], v[200:203], v[128:131]
    ds_read_b64_tr_b16 v[172:173], v9 offset:18528
    v_mfma_f32_16x16x32_bf16 v[132:135], v[176:179], v[204:207], v[132:135]
    ds_read_b64_tr_b16 v[174:175], v9 offset:19296
    v_mfma_f32_16x16x32_bf16 v[144:147], v[176:179], v[208:211], v[144:147]
    ds_read_b32 v251, v250
    v_mfma_f32_16x16x32_bf16 v[148:151], v[176:179], v[212:215], v[148:151]
    v_mfma_f32_16x16x32_bf16 v[136:139], v[180:183], v[200:203], v[136:139]
    ds_read_b64_tr_b16 v[176:177], v8 offset:12416
    v_mfma_f32_16x16x32_bf16 v[140:143], v[180:183], v[204:207], v[140:143]
    ds_read_b64_tr_b16 v[178:179], v8 offset:13184
    v_mfma_f32_16x16x32_bf16 v[152:155], v[180:183], v[208:211], v[152:155]
    v_mfma_f32_16x16x32_bf16 v[156:159], v[180:183], v[212:215], v[156:159]
    ds_read_b64_tr_b16 v[180:181], v8 offset:18592
    ds_read_b64_tr_b16 v[182:183], v8 offset:19360
    s_waitcnt lgkmcnt(4)
    v_mfma_f32_16x16x32_bf16 v[64:67], v[160:163], v[184:187], v[64:67]
    v_cmp_ne_u32 vcc, 0, v251
    v_mfma_f32_16x16x32_bf16 v[68:71], v[160:163], v[188:191], v[68:71]
    v_mfma_f32_16x16x32_bf16 v[80:83], v[160:163], v[192:195], v[80:83]
    s_getpc_b64 s[62:63]
    s_cbranch_vccnz L_stub
    v_mfma_f32_16x16x32_bf16 v[84:87], v[160:163], v[196:199], v[84:87]
    ds_read_b128 v[200:203], v13 offset:49152
    v_mfma_f32_16x16x32_bf16 v[72:75], v[164:167], v[184:187], v[72:75]
    ds_read_b64_tr_b16 v[160:161], v8 offset:24704
    v_mfma_f32_16x16x32_bf16 v[76:79], v[164:167], v[188:191], v[76:79]
    ds_read_b64_tr_b16 v[162:163], v8 offset:25472
    v_mfma_f32_16x16x32_bf16 v[88:91], v[164:167], v[192:195], v[88:91]
    ds_read_b128 v[204:207], v13 offset:51200
    v_mfma_f32_16x16x32_bf16 v[92:95], v[164:167], v[196:199], v[92:95]
    ds_read_b128 v[208:211], v13 offset:53248
    v_mfma_f32_16x16x32_bf16 v[96:99], v[168:171], v[184:187], v[96:99]
    s_waitcnt lgkmcnt(5)
    s_mov_b64 exec, 1
    buffer_load_dword v252, s[8:11], 0 offen offset:448 lds
    s_mov_b64 exec, -1
    s_nop 0
    v_mfma_f32_16x16x32_bf16 v[100:103], v[168:171], v[188:191], v[100:103]
    ds_read_b64_tr_b16 v[164:165], v8 offset:30880
    v_mfma_f32_16x16x32_bf16 v[112:115], v[168:171], v[192:195], v[112:115]
    ds_read_b64_tr_b16 v[166:167], v8 offset:31648
    v_mfma_f32_16x16x32_bf16 v[116:119], v[168:171], v[196:199], v[116:119]
    ds_read_b128 v[212:215], v13 offset:55296
    v_mfma_f32_16x16x32_bf16 v[104:107], v[172:175], v[184:187], v[104:107]
    ds_read_b64_tr_b16 v[168:169], v9 offset:24704
    v_mfma_f32_16x16x32_bf16 v[108:111], v[172:175], v[188:191], v[108:111]
    ds_read_b64_tr_b16 v[170:171], v9 offset:25472
    v_mfma_f32_16x16x32_bf16 v[120:123], v[172:175], v[192:195], v[120:123]
    v_mfma_f32_16x16x32_bf16 v[124:127], v[172:175], v[196:199], v[124:127]
    v_mov_b32_e64 v250, v18
    v_mfma_f32_16x16x32_bf16 v[128:131], v[176:179], v[184:187], v[128:131]
    ds_read_b64_tr_b16 v[172:173], v9 offset:30880
    v_mfma_f32_16x16x32_bf16 v[132:135], v[176:179], v[188:191], v[132:135]
    ds_read_b64_tr_b16 v[174:175], v9 offset:31648
    v_mfma_f32_16x16x32_bf16 v[144:147], v[176:179], v[192:195], v[144:147]
    ds_read_b32 v251, v250
    v_mfma_f32_16x16x32_bf16 v[148:151], v[176:179], v[196:199], v[148:151]
    v_mfma_f32_16x16x32_bf16 v[136:139], v[180:183], v[184:187], v[136:139]
    ds_read_b64_tr_b16 v[176:177], v8 offset:24768
    v_mfma_f32_16x16x32_bf16 v[140:143], v[180:183], v[188:191], v[140:143]
    ds_read_b64_tr_b16 v[178:179], v8 offset:25536
    v_mfma_f32_16x16x32_bf16 v[152:155], v[180:183], v[192:195], v[152:155]
    v_mfma_f32_16x16x32_bf16 v[156:159], v[180:183], v[196:199], v[156:159]
    ds_read_b64_tr_b16 v[180:181], v8 offset:30944
    ds_read_b64_tr_b16 v[182:183], v8 offset:31712
    s_waitcnt lgkmcnt(4)
    v_mfma_f32_16x16x32_bf16 v[64:67], v[160:163], v[200:203], v[64:67]
    v_cmp_ne_u32 vcc, 0, v251
    v_mfma_f32_16x16x32_bf16 v[68:71], v[160:163], v[204:207], v[68:71]
    v_mfma_f32_16x16x32_bf16 v[80:83], v[160:163], v[208:211], v[80:83]
    s_getpc_b64 s[62:63]
    s_cbranch_vccnz L_stub
    v_mfma_f32_16x16x32_bf16 v[84:87], v[160:163], v[212:215], v[84:87]
    ds_read_b64 v[216:217], v19 offset:0
    v_mfma_f32_16x16x32_bf16 v[72:75], v[164:167], v[200:203], v[72:75]
    ds_read_b64 v[218:219], v19 offset:128
    v_mfma_f32_16x16x32_bf16 v[76:79], v[164:167], v[204:207], v[76:79]
    ds_read_b64 v[220:221], v19 offset:256
    v_mfma_f32_16x16x32_bf16 v[88:91], v[164:167], v[208:211], v[88:91]
    ds_read_b64 v[222:223], v19 offset:384
    v_mfma_f32_16x16x32_bf16 v[92:95], v[164:167], v[212:215], v[92:95]
    ds_read2_b64 v[184:187], v17 offset0:0 offset1:16
    v_mfma_f32_16x16x32_bf16 v[96:99], v[168:171], v[200:203], v[96:99]
    s_waitcnt lgkmcnt(5)
    s_mov_b64 exec, 1
    buffer_load_dword v252, s[8:11], 0 offen offset:480 lds
    s_mov_b64 exec, -1
    s_nop 0
    v_mfma_f32_16x16x32_bf16 v[100:103], v[168:171], v[204:207], v[100:103]
    ds_read2_b64 v[188:191], v17 offset0:64 offset1:80
    v_mfma_f32_16x16x32_bf16 v[112:115], v[168:171], v[208:211], v[112:115]
    ds_read2_b64 v[192:195], v17 offset0:2 offset1:18
    v_mfma_f32_16x16x32_bf16 v[116:119], v[168:171], v[212:215], v[116:119]
    ds_read2_b64 v[196:199], v17 offset0:66 offset1:82
    v_mfma_f32_16x16x32_bf16 v[104:107], v[172:175], v[200:203], v[104:107]
    ds_read2_b64 v[224:227], v17 offset0:4 offset1:20
    v_mfma_f32_16x16x32_bf16 v[108:111], v[172:175], v[204:207], v[108:111]
    ds_read2_b64 v[228:231], v17 offset0:68 offset1:84
    v_mfma_f32_16x16x32_bf16 v[120:123], v[172:175], v[208:211], v[120:123]
    ds_read_b64 v[34:35], v36
    v_mfma_f32_16x16x32_bf16 v[124:127], v[172:175], v[212:215], v[124:127]
    v_mfma_f32_16x16x32_bf16 v[128:131], v[176:179], v[200:203], v[128:131]
    s_waitcnt lgkmcnt(0)
    v_readfirstlane_b32 s4, v34
    v_mfma_f32_16x16x32_bf16 v[132:135], v[176:179], v[204:207], v[132:135]
    v_readfirstlane_b32 s5, v35
    s_nop 0
    v_mfma_f32_16x16x32_bf16 v[144:147], v[176:179], v[208:211], v[144:147]
    v_mfma_f32_16x16x32_bf16 v[148:151], v[176:179], v[212:215], v[148:151]
    v_mfma_f32_16x16x32_bf16 v[136:139], v[180:183], v[200:203], v[136:139]
    v_mul_f32 v160, 0xbfb8aa3b, v217
    v_mfma_f32_16x16x32_bf16 v[140:143], v[180:183], v[204:207], v[140:143]
    v_mul_f32 v162, 0xbfb8aa3b, v219
    v_mfma_f32_16x16x32_bf16 v[152:155], v[180:183], v[208:211], v[152:155]
    v_mul_f32 v164, 0xbfb8aa3b, v221
    v_mfma_f32_16x16x32_bf16 v[156:159], v[180:183], v[212:215], v[156:159]
    v_mul_f32 v166, 0xbfb8aa3b, v223
    buffer_load_dwordx4 v[244:247], v249, s[8:11], 0 offen
    buffer_load_dword v248, v3, s[24:27], s38 offen sc1
    s_cmp_ge_u32 s36, 85
    s_cbranch_scc1 L_e1end
    s_nop 0
    v_pk_fma_f32 v[64:65], v[184:185], v[216:217], v[64:65] op_sel_hi:[1,0,1] neg_lo:[0,1,0] neg_hi:[0,1,0]
    v_pk_fma_f32 v[66:67], v[186:187], v[216:217], v[66:67] op_sel_hi:[1,0,1] neg_lo:[0,1,0] neg_hi:[0,1,0]
    v_pk_fma_f32 v[68:69], v[184:185], v[218:219], v[68:69] op_sel_hi:[1,0,1] neg_lo:[0,1,0] neg_hi:[0,1,0]
    v_pk_fma_f32 v[70:71], v[186:187], v[218:219], v[70:71] op_sel_hi:[1,0,1] neg_lo:[0,1,0] neg_hi:[0,1,0]
    v_pk_mul_f32 v[64:65], v[64:65], v[160:161] op_sel_hi:[1,0]
    v_pk_mul_f32 v[66:67], v[66:67], v[160:161] op_sel_hi:[1,0]
    v_pk_mul_f32 v[68:69], v[68:69], v[162:163] op_sel_hi:[1,0]
    v_pk_mul_f32 v[70:71], v[70:71], v[162:163] op_sel_hi:[1,0]
    v_exp_f32 v64, v64
    v_exp_f32 v65, v65
    v_exp_f32 v66, v66
    v_exp_f32 v67, v67
    v_exp_f32 v68, v68
    v_exp_f32 v69, v69
    v_exp_f32 v70, v70
    v_exp_f32 v71, v71
    v_pk_add_f32 v[64:65], v[64:65], v[26:27] op_sel_hi:[1,0]
    v_pk_add_f32 v[66:67], v[66:67], v[26:27] op_sel_hi:[1,0]
    v_pk_add_f32 v[68:69], v[68:69], v[26:27] op_sel_hi:[1,0]
    v_pk_add_f32 v[70:71], v[70:71], v[26:27] op_sel_hi:[1,0]
    v_rcp_f32 v64, v64
    v_rcp_f32 v65, v65
    v_rcp_f32 v66, v66
    v_rcp_f32 v67, v67
    v_rcp_f32 v68, v68
    v_rcp_f32 v69, v69
    v_rcp_f32 v70, v70
    v_rcp_f32 v71, v71
    v_pk_fma_f32 v[72:73], v[188:189], v[216:217], v[72:73] op_sel_hi:[1,0,1] neg_lo:[0,1,0] neg_hi:[0,1,0]
    v_pk_fma_f32 v[74:75], v[190:191], v[216:217], v[74:75] op_sel_hi:[1,0,1] neg_lo:[0,1,0] neg_hi:[0,1,0]
    v_pk_fma_f32 v[76:77], v[188:189], v[218:219], v[76:77] op_sel_hi:[1,0,1] neg_lo:[0,1,0] neg_hi:[0,1,0]
    v_pk_fma_f32 v[78:79], v[190:191], v[218:219], v[78:79] op_sel_hi:[1,0,1] neg_lo:[0,1,0] neg_hi:[0,1,0]
    v_pk_mul_f32 v[64:65], v[64:65], v[72:73]
    v_pk_mul_f32 v[66:67], v[66:67], v[74:75]
    v_pk_mul_f32 v[68:69], v[68:69], v[76:77]
    v_pk_mul_f32 v[70:71], v[70:71], v[78:79]
    v_cvt_pk_bf16_f32 v72, v64, v65
    v_cvt_pk_bf16_f32 v74, v68, v69
    v_cvt_pk_bf16_f32 v73, v66, v67
    v_cvt_pk_bf16_f32 v75, v70, v71
    v_permlane16_swap_b32 v72, v74
    s_nop 0
    v_permlane16_swap_b32 v73, v75
    s_nop 0
    buffer_store_dwordx4 v[72:75], v37, s[24:27], s34 offen offset:0 sc1
    v_pk_fma_f32 v[80:81], v[184:185], v[220:221], v[80:81] op_sel_hi:[1,0,1] neg_lo:[0,1,0] neg_hi:[0,1,0]
    v_pk_fma_f32 v[82:83], v[186:187], v[220:221], v[82:83] op_sel_hi:[1,0,1] neg_lo:[0,1,0] neg_hi:[0,1,0]
    v_pk_fma_f32 v[84:85], v[184:185], v[222:223], v[84:85] op_sel_hi:[1,0,1] neg_lo:[0,1,0] neg_hi:[0,1,0]
    v_pk_fma_f32 v[86:87], v[186:187], v[222:223], v[86:87] op_sel_hi:[1,0,1] neg_lo:[0,1,0] neg_hi:[0,1,0]
    v_pk_mul_f32 v[80:81], v[80:81], v[164:165] op_sel_hi:[1,0]
    v_pk_mul_f32 v[82:83], v[82:83], v[164:165] op_sel_hi:[1,0]
    v_pk_mul_f32 v[84:85], v[84:85], v[166:167] op_sel_hi:[1,0]
    v_pk_mul_f32 v[86:87], v[86:87], v[166:167] op_sel_hi:[1,0]
    v_exp_f32 v80, v80
    v_exp_f32 v81, v81
    v_exp_f32 v82, v82
    v_exp_f32 v83, v83
    v_exp_f32 v84, v84
    v_exp_f32 v85, v85
    v_exp_f32 v86, v86
    v_exp_f32 v87, v87
    v_pk_add_f32 v[80:81], v[80:81], v[26:27] op_sel_hi:[1,0]
    v_pk_add_f32 v[82:83], v[82:83], v[26:27] op_sel_hi:[1,0]
    v_pk_add_f32 v[84:85], v[84:85], v[26:27] op_sel_hi:[1,0]
    v_pk_add_f32 v[86:87], v[86:87], v[26:27] op_sel_hi:[1,0]
    v_rcp_f32 v80, v80
    v_rcp_f32 v81, v81
    v_rcp_f32 v82, v82
    v_rcp_f32 v83, v83
    v_rcp_f32 v84, v84
    v_rcp_f32 v85, v85
    v_rcp_f32 v86, v86
    v_rcp_f32 v87, v87
    v_pk_fma_f32 v[88:89], v[188:189], v[220:221], v[88:89] op_sel_hi:[1,0,1] neg_lo:[0,1,0] neg_hi:[0,1,0]
    v_pk_fma_f32 v[90:91], v[190:191], v[220:221], v[90:91] op_sel_hi:[1,0,1] neg_lo:[0,1,0] neg_hi:[0,1,0]
    v_pk_fma_f32 v[92:93], v[188:189], v[222:223], v[92:93] op_sel_hi:[1,0,1] neg_lo:[0,1,0] neg_hi:[0,1,0]
    v_pk_fma_f32 v[94:95], v[190:191], v[222:223], v[94:95] op_sel_hi:[1,0,1] neg_lo:[0,1,0] neg_hi:[0,1,0]
    v_pk_mul_f32 v[80:81], v[80:81], v[88:89]
    v_pk_mul_f32 v[82:83], v[82:83], v[90:91]
    v_pk_mul_f32 v[84:85], v[84:85], v[92:93]
    v_pk_mul_f32 v[86:87], v[86:87], v[94:95]
    v_cvt_pk_bf16_f32 v88, v80, v81
    v_cvt_pk_bf16_f32 v90, v84, v85
    v_cvt_pk_bf16_f32 v89, v82, v83
    v_cvt_pk_bf16_f32 v91, v86, v87
    v_permlane16_swap_b32 v88, v90
    s_nop 0
    v_permlane16_swap_b32 v89, v91
    s_nop 0
    buffer_store_dwordx4 v[88:91], v37, s[24:27], s35 offen offset:0 sc1
    v_pk_fma_f32 v[96:97], v[192:193], v[216:217], v[96:97] op_sel_hi:[1,0,1] neg_lo:[0,1,0] neg_hi:[0,1,0]
    v_pk_fma_f32 v[98:99], v[194:195], v[216:217], v[98:99] op_sel_hi:[1,0,1] neg_lo:[0,1,0] neg_hi:[0,1,0]
    v_pk_fma_f32 v[100:101], v[192:193], v[218:219], v[100:101] op_sel_hi:[1,0,1] neg_lo:[0,1,0] neg_hi:[0,1,0]
    v_pk_fma_f32 v[102:103], v[194:195], v[218:219], v[102:103] op_sel_hi:[1,0,1] neg_lo:[0,1,0] neg_hi:[0,1,0]
    v_pk_mul_f32 v[96:97], v[96:97], v[160:161] op_sel_hi:[1,0]
    v_pk_mul_f32 v[98:99], v[98:99], v[160:161] op_sel_hi:[1,0]
    v_pk_mul_f32 v[100:101], v[100:101], v[162:163] op_sel_hi:[1,0]
    v_pk_mul_f32 v[102:103], v[102:103], v[162:163] op_sel_hi:[1,0]
    v_exp_f32 v96, v96
    v_exp_f32 v97, v97
    v_exp_f32 v98, v98
    v_exp_f32 v99, v99
    v_exp_f32 v100, v100
    v_exp_f32 v101, v101
    v_exp_f32 v102, v102
    v_exp_f32 v103, v103
    v_pk_add_f32 v[96:97], v[96:97], v[26:27] op_sel_hi:[1,0]
    v_pk_add_f32 v[98:99], v[98:99], v[26:27] op_sel_hi:[1,0]
    v_pk_add_f32 v[100:101], v[100:101], v[26:27] op_sel_hi:[1,0]
    v_pk_add_f32 v[102:103], v[102:103], v[26:27] op_sel_hi:[1,0]
    v_rcp_f32 v96, v96
    v_rcp_f32 v97, v97
    v_rcp_f32 v98, v98
    v_rcp_f32 v99, v99
    v_rcp_f32 v100, v100
    v_rcp_f32 v101, v101
    v_rcp_f32 v102, v102
    v_rcp_f32 v103, v103
    v_pk_fma_f32 v[104:105], v[196:197], v[216:217], v[104:105] op_sel_hi:[1,0,1] neg_lo:[0,1,0] neg_hi:[0,1,0]
    v_pk_fma_f32 v[106:107], v[198:199], v[216:217], v[106:107] op_sel_hi:[1,0,1] neg_lo:[0,1,0] neg_hi:[0,1,0]
    v_pk_fma_f32 v[108:109], v[196:197], v[218:219], v[108:109] op_sel_hi:[1,0,1] neg_lo:[0,1,0] neg_hi:[0,1,0]
    v_pk_fma_f32 v[110:111], v[198:199], v[218:219], v[110:111] op_sel_hi:[1,0,1] neg_lo:[0,1,0] neg_hi:[0,1,0]
    v_pk_mul_f32 v[96:97], v[96:97], v[104:105]
    v_pk_mul_f32 v[98:99], v[98:99], v[106:107]
    v_pk_mul_f32 v[100:101], v[100:101], v[108:109]
    v_pk_mul_f32 v[102:103], v[102:103], v[110:111]
    v_cvt_pk_bf16_f32 v104, v96, v97
    v_cvt_pk_bf16_f32 v106, v100, v101
    v_cvt_pk_bf16_f32 v105, v98, v99
    v_cvt_pk_bf16_f32 v107, v102, v103
    v_permlane16_swap_b32 v104, v106
    s_nop 0
    v_permlane16_swap_b32 v105, v107
    s_nop 0
    buffer_store_dwordx4 v[104:107], v37, s[24:27], s34 offen offset:1024 sc1
    v_pk_fma_f32 v[112:113], v[192:193], v[220:221], v[112:113] op_sel_hi:[1,0,1] neg_lo:[0,1,0] neg_hi:[0,1,0]
    v_pk_fma_f32 v[114:115], v[194:195], v[220:221], v[114:115] op_sel_hi:[1,0,1] neg_lo:[0,1,0] neg_hi:[0,1,0]
    v_pk_fma_f32 v[116:117], v[192:193], v[222:223], v[116:117] op_sel_hi:[1,0,1] neg_lo:[0,1,0] neg_hi:[0,1,0]
    v_pk_fma_f32 v[118:119], v[194:195], v[222:223], v[118:119] op_sel_hi:[1,0,1] neg_lo:[0,1,0] neg_hi:[0,1,0]
    v_pk_mul_f32 v[112:113], v[112:113], v[164:165] op_sel_hi:[1,0]
    v_pk_mul_f32 v[114:115], v[114:115], v[164:165] op_sel_hi:[1,0]
    v_pk_mul_f32 v[116:117], v[116:117], v[166:167] op_sel_hi:[1,0]
    v_pk_mul_f32 v[118:119], v[118:119], v[166:167] op_sel_hi:[1,0]
    v_exp_f32 v112, v112
    v_exp_f32 v113, v113
    v_exp_f32 v114, v114
    v_exp_f32 v115, v115
    v_exp_f32 v116, v116
    v_exp_f32 v117, v117
    v_exp_f32 v118, v118
    v_exp_f32 v119, v119
    v_pk_add_f32 v[112:113], v[112:113], v[26:27] op_sel_hi:[1,0]
    v_pk_add_f32 v[114:115], v[114:115], v[26:27] op_sel_hi:[1,0]
    v_pk_add_f32 v[116:117], v[116:117], v[26:27] op_sel_hi:[1,0]
    v_pk_add_f32 v[118:119], v[118:119], v[26:27] op_sel_hi:[1,0]
    v_rcp_f32 v112, v112
    v_rcp_f32 v113, v113
    v_rcp_f32 v114, v114
    v_rcp_f32 v115, v115
    v_rcp_f32 v116, v116
    v_rcp_f32 v117, v117
    v_rcp_f32 v118, v118
    v_rcp_f32 v119, v119
    v_pk_fma_f32 v[120:121], v[196:197], v[220:221], v[120:121] op_sel_hi:[1,0,1] neg_lo:[0,1,0] neg_hi:[0,1,0]
    v_pk_fma_f32 v[122:123], v[198:199], v[220:221], v[122:123] op_sel_hi:[1,0,1] neg_lo:[0,1,0] neg_hi:[0,1,0]
    v_pk_fma_f32 v[124:125], v[196:197], v[222:223], v[124:125] op_sel_hi:[1,0,1] neg_lo:[0,1,0] neg_hi:[0,1,0]
    v_pk_fma_f32 v[126:127], v[198:199], v[222:223], v[126:127] op_sel_hi:[1,0,1] neg_lo:[0,1,0] neg_hi:[0,1,0]
    v_pk_mul_f32 v[112:113], v[112:113], v[120:121]
    v_pk_mul_f32 v[114:115], v[114:115], v[122:123]
    v_pk_mul_f32 v[116:117], v[116:117], v[124:125]
    v_pk_mul_f32 v[118:119], v[118:119], v[126:127]
    v_cvt_pk_bf16_f32 v120, v112, v113
    v_cvt_pk_bf16_f32 v122, v116, v117
    v_cvt_pk_bf16_f32 v121, v114, v115
    v_cvt_pk_bf16_f32 v123, v118, v119
    v_permlane16_swap_b32 v120, v122
    s_nop 0
    v_permlane16_swap_b32 v121, v123
    buffer_store_dwordx4 v[120:123], v37, s[24:27], s35 offen offset:1024 sc1
    s_cmp_ge_u32 s36, 84
    s_cbranch_scc1 L_e1end
    v_pk_fma_f32 v[128:129], v[224:225], v[216:217], v[128:129] op_sel_hi:[1,0,1] neg_lo:[0,1,0] neg_hi:[0,1,0]
    v_pk_fma_f32 v[130:131], v[226:227], v[216:217], v[130:131] op_sel_hi:[1,0,1] neg_lo:[0,1,0] neg_hi:[0,1,0]
    v_pk_fma_f32 v[132:133], v[224:225], v[218:219], v[132:133] op_sel_hi:[1,0,1] neg_lo:[0,1,0] neg_hi:[0,1,0]
    v_pk_fma_f32 v[134:135], v[226:227], v[218:219], v[134:135] op_sel_hi:[1,0,1] neg_lo:[0,1,0] neg_hi:[0,1,0]
    v_pk_mul_f32 v[128:129], v[128:129], v[160:161] op_sel_hi:[1,0]
    v_pk_mul_f32 v[130:131], v[130:131], v[160:161] op_sel_hi:[1,0]
    v_pk_mul_f32 v[132:133], v[132:133], v[162:163] op_sel_hi:[1,0]
    v_pk_mul_f32 v[134:135], v[134:135], v[162:163] op_sel_hi:[1,0]
    v_exp_f32 v128, v128
    v_exp_f32 v129, v129
    v_exp_f32 v130, v130
    v_exp_f32 v131, v131
    v_exp_f32 v132, v132
    v_exp_f32 v133, v133
    v_exp_f32 v134, v134
    v_exp_f32 v135, v135
    v_pk_add_f32 v[128:129], v[128:129], v[26:27] op_sel_hi:[1,0]
    v_pk_add_f32 v[130:131], v[130:131], v[26:27] op_sel_hi:[1,0]
    v_pk_add_f32 v[132:133], v[132:133], v[26:27] op_sel_hi:[1,0]
    v_pk_add_f32 v[134:135], v[134:135], v[26:27] op_sel_hi:[1,0]
    v_rcp_f32 v128, v128
    v_rcp_f32 v129, v129
    v_rcp_f32 v130, v130
    v_rcp_f32 v131, v131
    v_rcp_f32 v132, v132
    v_rcp_f32 v133, v133
    v_rcp_f32 v134, v134
    v_rcp_f32 v135, v135
    v_pk_fma_f32 v[136:137], v[228:229], v[216:217], v[136:137] op_sel_hi:[1,0,1] neg_lo:[0,1,0] neg_hi:[0,1,0]
    v_pk_fma_f32 v[138:139], v[230:231], v[216:217], v[138:139] op_sel_hi:[1,0,1] neg_lo:[0,1,0] neg_hi:[0,1,0]
    v_pk_fma_f32 v[140:141], v[228:229], v[218:219], v[140:141] op_sel_hi:[1,0,1] neg_lo:[0,1,0] neg_hi:[0,1,0]
    v_pk_fma_f32 v[142:143], v[230:231], v[218:219], v[142:143] op_sel_hi:[1,0,1] neg_lo:[0,1,0] neg_hi:[0,1,0]
    v_pk_mul_f32 v[128:129], v[128:129], v[136:137]
    v_pk_mul_f32 v[130:131], v[130:131], v[138:139]
    v_pk_mul_f32 v[132:133], v[132:133], v[140:141]
    v_pk_mul_f32 v[134:135], v[134:135], v[142:143]
    v_cvt_pk_bf16_f32 v136, v128, v129
    v_cvt_pk_bf16_f32 v138, v132, v133
    v_cvt_pk_bf16_f32 v137, v130, v131
    v_cvt_pk_bf16_f32 v139, v134, v135
    v_permlane16_swap_b32 v136, v138
    s_nop 0
    v_permlane16_swap_b32 v137, v139
    s_nop 0
    buffer_store_dwordx4 v[136:139], v37, s[24:27], s34 offen offset:2048 sc1
    v_pk_fma_f32 v[144:145], v[224:225], v[220:221], v[144:145] op_sel_hi:[1,0,1] neg_lo:[0,1,0] neg_hi:[0,1,0]
    v_pk_fma_f32 v[146:147], v[226:227], v[220:221], v[146:147] op_sel_hi:[1,0,1] neg_lo:[0,1,0] neg_hi:[0,1,0]
    v_pk_fma_f32 v[148:149], v[224:225], v[222:223], v[148:149] op_sel_hi:[1,0,1] neg_lo:[0,1,0] neg_hi:[0,1,0]
    v_pk_fma_f32 v[150:151], v[226:227], v[222:223], v[150:151] op_sel_hi:[1,0,1] neg_lo:[0,1,0] neg_hi:[0,1,0]
    v_pk_mul_f32 v[144:145], v[144:145], v[164:165] op_sel_hi:[1,0]
    v_pk_mul_f32 v[146:147], v[146:147], v[164:165] op_sel_hi:[1,0]
    v_pk_mul_f32 v[148:149], v[148:149], v[166:167] op_sel_hi:[1,0]
    v_pk_mul_f32 v[150:151], v[150:151], v[166:167] op_sel_hi:[1,0]
    v_exp_f32 v144, v144
    v_mov_b32 v250, v2
    v_exp_f32_e64 v145, v145
    ds_read_b32 v251, v250
    v_exp_f32 v146, v146
    v_exp_f32 v147, v147
    v_exp_f32 v148, v148
    v_exp_f32 v149, v149
    v_exp_f32 v150, v150
    v_exp_f32 v151, v151
    v_pk_add_f32 v[144:145], v[144:145], v[26:27] op_sel_hi:[1,0]
    v_pk_add_f32 v[146:147], v[146:147], v[26:27] op_sel_hi:[1,0]
    v_pk_add_f32 v[148:149], v[148:149], v[26:27] op_sel_hi:[1,0]
    v_pk_add_f32 v[150:151], v[150:151], v[26:27] op_sel_hi:[1,0]
    v_rcp_f32 v144, v144
    v_rcp_f32 v145, v145
    v_rcp_f32 v146, v146
    v_rcp_f32 v147, v147
    v_rcp_f32 v148, v148
    v_rcp_f32 v149, v149
    v_rcp_f32 v150, v150
    v_rcp_f32 v151, v151
    v_pk_fma_f32 v[152:153], v[228:229], v[220:221], v[152:153] op_sel_hi:[1,0,1] neg_lo:[0,1,0] neg_hi:[0,1,0]
    v_pk_fma_f32 v[154:155], v[230:231], v[220:221], v[154:155] op_sel_hi:[1,0,1] neg_lo:[0,1,0] neg_hi:[0,1,0]
    v_pk_fma_f32 v[156:157], v[228:229], v[222:223], v[156:157] op_sel_hi:[1,0,1] neg_lo:[0,1,0] neg_hi:[0,1,0]
    v_pk_fma_f32 v[158:159], v[230:231], v[222:223], v[158:159] op_sel_hi:[1,0,1] neg_lo:[0,1,0] neg_hi:[0,1,0]
    v_pk_mul_f32 v[144:145], v[144:145], v[152:153]
    v_pk_mul_f32 v[146:147], v[146:147], v[154:155]
    v_pk_mul_f32 v[148:149], v[148:149], v[156:157]
    v_pk_mul_f32 v[150:151], v[150:151], v[158:159]
    v_cvt_pk_bf16_f32 v152, v144, v145
    v_cvt_pk_bf16_f32 v154, v148, v149
    v_cvt_pk_bf16_f32 v153, v146, v147
    v_cvt_pk_bf16_f32 v155, v150, v151
    v_permlane16_swap_b32 v152, v154
    s_nop 0
    v_permlane16_swap_b32 v153, v155
    buffer_store_dwordx4 v[152:155], v37, s[24:27], s35 offen offset:2048 sc1
L_e2end:
    s_setprio 2
    s_mov_b32 s46, 0
    s_waitcnt lgkmcnt(0)
    v_cmp_ne_u32_e64 vcc, 0, v251
    s_getpc_b64 s[62:63]
    s_cbranch_vccnz L_stub
    s_add_u32 s32, s39, 512
    v_mov_b32 v251, s32
    s_mov_b64 exec, 1
    ds_write_b32 v251, v253
    s_mov_b64 exec, -1
    v_and_b32 v250, 1, v1
    v_lshlrev_b32_e64 v250, 2, v250
    v_add_u32 v250, 162928, v250
    s_add_u32 m0, s45, 94208
    s_add_u32 s44, s44, 16384
    buffer_load_dwordx4 v46, s[20:23], s44 offen lds
    s_add_u32 m0, s45, 98304
    s_add_u32 s44, s44, 16384
    buffer_load_dwordx4 v46, s[20:23], s44 offen lds
    s_add_u32 m0, s45, 102400
    s_add_u32 s44, s44, 16384
    buffer_load_dwordx4 v46, s[20:23], s44 offen lds
    s_add_u32 m0, s45, 106496
    s_add_u32 s44, s44, 16384
    buffer_load_dwordx4 v46, s[20:23], s44 offen lds
    s_add_u32 m0, s45, 12288
    s_add_u32 s44, s44, 16384
    buffer_load_dwordx4 v46, s[20:23], s44 offen lds
    s_add_u32 m0, s45, 16384
    s_add_u32 s44, s44, 16384
    buffer_load_dwordx4 v46, s[20:23], s44 offen lds
    s_add_u32 m0, s45, 20480
    s_add_u32 s44, s44, 16384
    buffer_load_dwordx4 v46, s[20:23], s44 offen lds
    s_add_u32 m0, s45, 24576
    s_add_u32 s44, s44, 16384
    buffer_load_dwordx4 v46, s[20:23], s44 offen lds
    s_add_u32 m0, s45, 28672
    s_add_u32 s44, s44, 16384
    buffer_load_dwordx4 v46, s[20:23], s44 offen lds
    s_add_u32 m0, s45, 32768
    s_add_u32 s44, s44, 16384
    buffer_load_dwordx4 v46, s[20:23], s44 offen lds
    s_add_u32 m0, s45, 36864
    s_add_u32 s44, s44, 16384
    buffer_load_dwordx4 v46, s[20:23], s44 offen lds
    s_waitcnt vmcnt(11)
    s_cmp_eq_u32 s46, 1
    s_cbranch_scc1 L_f2
    s_mov_b64 s[6:7], s[4:5]
    s_atomic_swap_x2 s[6:7], s[94:95], s37
    s_cmp_lg_u32 s36, 42
    s_cbranch_scc1 L_f2
    s_add_u32 s37, s37, 144
    s_mov_b64 s[34:35], s[4:5]
    s_atomic_swap_x2 s[34:35], s[94:95], s37
L_f2:
    s_mov_b32 m0, s39
    s_mov_b64 exec, 1
    buffer_load_dword v252, s[8:11], 0 offen offset:864 lds
    s_mov_b64 exec, -1
    ds_read_b32 v251, v250
    ds_read_b32 v14, v250
    ds_read_b32 v14, v250
    ds_read_b32 v14, v250
    ds_read_b32 v14, v250
    s_waitcnt lgkmcnt(4)
    v_cmp_ne_u32 vcc, 0, v251
    s_getpc_b64 s[62:63]
    s_cbranch_vccnz L_stub
    ds_read_b64_tr_b16 v[48:49], v40 offset:0
    ds_read_b64_tr_b16 v[50:51], v40 offset:512
    ds_read_b64_tr_b16 v[52:53], v41 offset:0
    ds_read_b64_tr_b16 v[54:55], v41 offset:512
    ds_read_b64_tr_b16 v[56:57], v40 offset:4096
    ds_read_b64_tr_b16 v[58:59], v40 offset:4608
    ds_read_b64_tr_b16 v[60:61], v41 offset:4096
    ds_read_b64_tr_b16 v[62:63], v41 offset:4608
    ds_read_b64_tr_b16 v[64:65], v40 offset:8192
    ds_read_b64_tr_b16 v[66:67], v40 offset:8704
    ds_read_b64_tr_b16 v[68:69], v41 offset:8192
    ds_read_b64_tr_b16 v[70:71], v41 offset:8704
    ds_read_b64_tr_b16 v[72:73], v38 offset:40960
    ds_read_b64_tr_b16 v[74:75], v38 offset:41472
    ds_read_b64_tr_b16 v[76:77], v39 offset:40960
    ds_read_b64_tr_b16 v[78:79], v39 offset:41472
    ds_read_b64_tr_b16 v[80:81], v38 offset:45056
    ds_read_b64_tr_b16 v[82:83], v38 offset:45568
    ds_read_b64_tr_b16 v[84:85], v39 offset:45056
    ds_read_b64_tr_b16 v[86:87], v39 offset:45568
    ds_read_b64_tr_b16 v[88:89], v38 offset:49152
    ds_read_b64_tr_b16 v[90:91], v38 offset:49664
    ds_read_b64_tr_b16 v[92:93], v39 offset:49152
    ds_read_b64_tr_b16 v[94:95], v39 offset:49664
    ds_read_b64_tr_b16 v[176:177], v38 offset:53248
    ds_read_b64_tr_b16 v[178:179], v38 offset:53760
    ds_read_b64_tr_b16 v[180:181], v39 offset:53248
    ds_read_b64_tr_b16 v[182:183], v39 offset:53760
    ds_read_b64_tr_b16 v[184:185], v38 offset:57344
    ds_read_b64_tr_b16 v[186:187], v38 offset:57856
    ds_read_b64_tr_b16 v[188:189], v39 offset:57344
    ds_read_b64_tr_b16 v[190:191], v39 offset:57856
    ds_read_b64_tr_b16 v[192:193], v38 offset:61440
    ds_read_b64_tr_b16 v[194:195], v38 offset:61952
    ds_read_b64_tr_b16 v[196:197], v39 offset:61440
    ds_read_b64_tr_b16 v[198:199], v39 offset:61952
    ds_read_b64_tr_b16 v[200:201], v40 offset:12288
    ds_read_b64_tr_b16 v[202:203], v40 offset:12800
    ds_read_b64_tr_b16 v[204:205], v41 offset:12288
    ds_read_b64_tr_b16 v[206:207], v41 offset:12800
    ds_read_b64_tr_b16 v[208:209], v40 offset:16384
    ds_read_b64_tr_b16 v[210:211], v40 offset:16896
    ds_read_b64_tr_b16 v[212:213], v41 offset:16384
    ds_read_b64_tr_b16 v[214:215], v41 offset:16896
    ds_read_b64_tr_b16 v[160:161], v40 offset:20480
    ds_read_b64_tr_b16 v[162:163], v40 offset:20992
    ds_read_b64_tr_b16 v[164:165], v41 offset:20480
    ds_read_b64_tr_b16 v[166:167], v41 offset:20992
    ds_read_b64_tr_b16 v[96:97], v40 offset:24576
    ds_read_b64_tr_b16 v[98:99], v40 offset:25088
    ds_read_b64_tr_b16 v[100:101], v41 offset:24576
    ds_read_b64_tr_b16 v[102:103], v41 offset:25088
    ds_read_b64_tr_b16 v[104:105], v38 offset:0
    ds_read_b64_tr_b16 v[106:107], v38 offset:512
    ds_read_b64_tr_b16 v[108:109], v39 offset:0
    ds_read_b64_tr_b16 v[110:111], v39 offset:512
    ds_read_b64_tr_b16 v[112:113], v38 offset:4096
    ds_read_b64_tr_b16 v[114:115], v38 offset:4608
    ds_read_b64_tr_b16 v[116:117], v39 offset:4096
    ds_read_b64_tr_b16 v[118:119], v39 offset:4608
    ds_read_b64_tr_b16 v[120:121], v38 offset:8192
    ds_read_b64_tr_b16 v[122:123], v38 offset:8704
    ds_read_b64_tr_b16 v[124:125], v39 offset:8192
    ds_read_b64_tr_b16 v[126:127], v39 offset:8704
    s_add_u32 s32, s39, 544
    v_mov_b32 v251, s32
    s_mov_b64 exec, 1
    ds_write_b32 v251, v253
    s_mov_b64 exec, -1
    s_xor_b32 s32, s32, 4
    v_mov_b32_e64 v250, s32
    ds_read_b32 v251, v250
    ds_read_b32 v14, v250
    ds_read_b32 v14, v250
    ds_read_b32 v14, v250
    ds_read_b32 v14, v250
    s_waitcnt lgkmcnt(4)
    v_cmp_ne_u32 vcc, 0, v251
    s_getpc_b64 s[62:63]
    s_cbranch_vccnz L_stub
    s_add_u32 m0, s45, 65536
    s_add_u32 s44, s44, 16384
    buffer_load_dwordx4 v46, s[20:23], s44 offen lds
    s_add_u32 m0, s45, 69632
    s_add_u32 s44, s44, 16384
    buffer_load_dwordx4 v46, s[20:23], s44 offen lds
    s_add_u32 m0, s45, 73728
    s_add_u32 s44, s44, 16384
    buffer_load_dwordx4 v46, s[20:23], s44 offen lds
    s_add_u32 m0, s45, 40960
    s_add_u32 s44, s44, 16384
    buffer_load_dwordx4 v46, s[20:23], s44 offen lds
    s_add_u32 m0, s45, 45056
    s_add_u32 s44, s44, 16384
    buffer_load_dwordx4 v46, s[20:23], s44 offen lds
    s_add_u32 m0, s45, 49152
    s_add_u32 s44, s44, 16384
    buffer_load_dwordx4 v46, s[20:23], s44 offen lds
    s_add_u32 m0, s45, 53248
    s_add_u32 s44, s44, 16384
    buffer_load_dwordx4 v46, s[20:23], s44 offen lds
    s_add_u32 m0, s45, 57344
    s_add_u32 s44, s44, 16384
    buffer_load_dwordx4 v46, s[20:23], s44 offen lds
    s_load_dwordx16 s[64:79], s[100:101], s47 glc
    s_add_u32 s32, s47, 64
    s_nop 0
    s_load_dwordx16 s[80:95], s[100:101], s32 glc
    s_add_u32 m0, s45, 61440
    s_add_u32 s44, s44, 16384
    buffer_load_dwordx4 v46, s[20:23], s44 offen lds
    s_add_u32 m0, s45, 77824
    s_add_u32 s44, s44, 16384
    buffer_load_dwordx4 v46, s[20:23], s44 offen lds
    s_add_u32 m0, s45, 81920
    s_add_u32 s44, s44, 16384
    buffer_load_dwordx4 v46, s[20:23], s44 offen lds
    s_add_u32 m0, s45, 86016
    s_add_u32 s44, s44, 16384
    buffer_load_dwordx4 v46, s[20:23], s44 offen lds
    s_add_u32 m0, s45, 90112
    s_add_u32 s44, s44, 16384
    buffer_load_dwordx4 v46, s[20:23], s44 offen lds
    s_add_u32 m0, s45, 0
    s_nop 0
    s_add_u32 s44, s44, 16384
    buffer_load_dwordx4 v46, s[20:23], s44 offen lds
    s_add_u32 m0, s45, 4096
    s_add_u32 s44, s44, 16384
    buffer_load_dwordx4 v46, s[20:23], s44 offen lds
    s_add_u32 m0, s45, 8192
    s_add_u32 s44, s44, 16384
    buffer_load_dwordx4 v46, s[20:23], s44 offen lds
    s_mov_b32 m0, s39
    s_mov_b64 exec, 1
    buffer_load_dword v252, s[8:11], 0 offen offset:576 lds
    s_mov_b64 exec, -1
    v_mov_b32 v4, v38
    v_mov_b32 v5, v39
    v_mov_b32 v6, v40
    v_mov_b32 v7, v41
    v_mov_b32 v8, v47
    s_mov_b32 s46, 0
L_sph:
    s_waitcnt lgkmcnt(0)
    s_cmp_lg_u64 s[64:65], s[4:5]
    s_cbranch_scc1 L_srh
    s_cmp_lg_u64 s[66:67], s[4:5]
    s_cbranch_scc1 L_srh
    s_cmp_lg_u64 s[68:69], s[4:5]
    s_cbranch_scc1 L_srh
    s_cmp_lg_u64 s[70:71], s[4:5]
    s_cbranch_scc1 L_srh
    s_cmp_lg_u64 s[72:73], s[4:5]
    s_cbranch_scc1 L_srh
    s_cmp_lg_u64 s[74:75], s[4:5]
    s_cbranch_scc1 L_srh
    s_cmp_lg_u64 s[76:77], s[4:5]
    s_cbranch_scc1 L_srh
    s_cmp_lg_u64 s[78:79], s[4:5]
    s_cbranch_scc1 L_srh
    s_cmp_lg_u64 s[80:81], s[4:5]
    s_cbranch_scc1 L_srh
    s_cmp_lg_u64 s[82:83], s[4:5]
    s_cbranch_scc1 L_srh
    s_cmp_lg_u64 s[84:85], s[4:5]
    s_cbranch_scc1 L_srh
    s_cmp_lg_u64 s[86:87], s[4:5]
    s_cbranch_scc1 L_srh
    s_cmp_lg_u64 s[88:89], s[4:5]
    s_cbranch_scc1 L_srh
    s_cmp_lg_u64 s[90:91], s[4:5]
    s_cbranch_scc1 L_srh
    s_cmp_lg_u64 s[92:93], s[4:5]
    s_cbranch_scc1 L_srh
L_soh:
    buffer_load_dwordx4 v[168:171], v8, s[24:27], s40 offen offset:0 sc1
    buffer_load_dwordx4 v[172:175], v8, s[24:27], s40 offen offset:1024 sc1
    buffer_load_dwordx4 v[216:219], v8, s[24:27], s40 offen offset:2048 sc1
    buffer_load_dwordx4 v[220:223], v8, s[24:27], s40 offen offset:3072 sc1
    s_add_u32 s40, s40, 4096
    buffer_load_dwordx4 v[224:227], v8, s[24:27], s40 offen offset:0 sc1
    buffer_load_dwordx4 v[228:231], v8, s[24:27], s40 offen offset:1024 sc1
    buffer_load_dwordx4 v[232:235], v8, s[24:27], s40 offen offset:2048 sc1
    buffer_load_dwordx4 v[236:239], v8, s[24:27], s40 offen offset:3072 sc1
    s_add_u32 s40, s40, 4096
    buffer_load_dwordx4 v[240:243], v8, s[24:27], s40 offen offset:0 sc1
    buffer_load_dwordx4 v[144:147], v8, s[24:27], s40 offen offset:1024 sc1
    buffer_load_dwordx4 v[148:151], v8, s[24:27], s40 offen offset:2048 sc1
    buffer_load_dwordx4 v[152:155], v8, s[24:27], s40 offen offset:3072 sc1
    s_add_u32 s40, s40, 4096
    buffer_load_dwordx4 v[156:159], v8, s[24:27], s40 offen offset:0 sc1
    s_setprio 0
    s_waitcnt vmcnt(12)
    v_mfma_f32_32x32x16_bf16 v[16:31], v[48:51], v[168:171], 0
    s_lshr_b32 s34, s3, 1
    v_and_b32 v128, 15, v1
    v_mul_u32_u24 v128, 272, v128
    v_and_b32_e64 v129, 48, v1
    v_mfma_f32_32x32x16_bf16 v[32:47], v[52:55], v[168:171], 0
    v_lshl_add_u32 v128, v129, 1, v128
    s_mul_i32 s35, s34, 4352
    s_lshl_b32 s43, s57, 7
    s_add_u32 s35, s35, s43
    buffer_load_dwordx4 v[168:171], v8, s[24:27], s40 offen offset:1024 sc1
    s_waitcnt vmcnt(12)
    v_mfma_f32_32x32x16_bf16 v[16:31], v[56:59], v[172:175], v[16:31]
    s_add_u32 s35, s35, 110912
    v_add_u32 v128, s35, v128
    v_lshlrev_b32_e64 v129, 6, v129
    v_bfe_u32 v130, v1, 2, 2
    v_mfma_f32_32x32x16_bf16 v[32:47], v[60:63], v[172:175], v[32:47]
    v_lshl_add_u32 v129, v130, 7, v129
    v_and_b32_e64 v130, 1, v1
    v_lshl_add_u32 v129, v130, 3, v129
    v_bfe_u32 v130, v1, 1, 1
    buffer_load_dwordx4 v[172:175], v8, s[24:27], s40 offen offset:2048 sc1
    s_waitcnt vmcnt(12)
    v_mfma_f32_32x32x16_bf16 v[16:31], v[64:67], v[216:219], v[16:31]
    v_lshl_add_u32 v129, v130, 6, v129
    s_lshl_b32 s35, s57, 12
    s_lshl_b32 s43, s34, 4
    s_add_u32 s35, s35, s43
    v_mfma_f32_32x32x16_bf16 v[32:47], v[68:71], v[216:219], v[32:47]
    s_add_u32 s35, s35, 153920
    v_add_u32_e64 v129, s35, v129
    v_mul_f32 v130, 0xbfb8aa3b, v248
    v_mov_b32_e64 v132, 1.0
    buffer_load_dwordx4 v[216:219], v8, s[24:27], s40 offen offset:3072 sc1
    s_waitcnt vmcnt(12)
    v_mfma_f32_32x32x16_bf16 v[16:31], v[72:75], v[220:223], v[16:31]
    v_lshlrev_b32 v136, 16, v244
    v_and_b32 v137, 0xffff0000, v244
    v_lshlrev_b32_e64 v138, 16, v245
    v_and_b32 v139, 0xffff0000, v245
    v_mfma_f32_32x32x16_bf16 v[32:47], v[76:79], v[220:223], v[32:47]
    v_lshlrev_b32_e64 v140, 16, v246
    v_and_b32 v141, 0xffff0000, v246
    v_lshlrev_b32_e64 v142, 16, v247
    v_and_b32 v143, 0xffff0000, v247
    s_add_u32 s40, s40, 4096
    buffer_load_dwordx4 v[220:223], v8, s[24:27], s40 offen offset:0 sc1
    s_waitcnt vmcnt(12)
    v_mfma_f32_32x32x16_bf16 v[16:31], v[80:83], v[224:227], v[16:31]
    v_and_b32 v134, 3, v1
    v_lshrrev_b32 v133, 2, v1
    v_lshlrev_b32 v135, 4, v134
    v_add_lshl_u32 v134, v135, v133, 2
    v_mfma_f32_32x32x16_bf16 v[32:47], v[84:87], v[224:227], v[32:47]
    v_lshl_add_u32 v135, v133, 10, v135
    v_readfirstlane_b32 s35, v249
    s_nop 1
    v_add_u32_e64 v135, s35, v135
    buffer_load_dwordx4 v[224:227], v8, s[24:27], s40 offen offset:1024 sc1
    s_waitcnt vmcnt(12)
    v_mfma_f32_32x32x16_bf16 v[16:31], v[88:91], v[228:231], v[16:31]
    v_and_b32 v10, 31, v1
    v_mul_u32_u24 v10, 272, v10
    v_lshrrev_b32 v11, 5, v1
    v_lshlrev_b32 v11, 4, v11
    v_mfma_f32_32x32x16_bf16 v[32:47], v[92:95], v[228:231], v[32:47]
    s_mul_i32 s35, s3, 8704
    s_add_u32 s35, s35, 110912
    v_add3_u32 v10, v10, v11, s35
    buffer_load_dwordx4 v[228:231], v8, s[24:27], s40 offen offset:2048 sc1
    s_waitcnt vmcnt(12)
    s_nop 0
    v_mfma_f32_32x32x16_bf16 v[16:31], v[176:179], v[232:235], v[16:31]
    v_mfma_f32_32x32x16_bf16 v[32:47], v[180:183], v[232:235], v[32:47]
    buffer_load_dwordx4 v[232:235], v8, s[24:27], s40 offen offset:3072 sc1
    s_waitcnt vmcnt(12)
    s_nop 0
    v_mfma_f32_32x32x16_bf16 v[16:31], v[184:187], v[236:239], v[16:31]
    v_mfma_f32_32x32x16_bf16 v[32:47], v[188:191], v[236:239], v[32:47]
    s_add_u32 s40, s40, 4096
    buffer_load_dwordx4 v[236:239], v8, s[24:27], s40 offen offset:0 sc1
    s_waitcnt vmcnt(12)
    s_nop 0
    v_mfma_f32_32x32x16_bf16 v[16:31], v[192:195], v[240:243], v[16:31]
    v_mfma_f32_32x32x16_bf16 v[32:47], v[196:199], v[240:243], v[32:47]
    buffer_load_dwordx4 v[240:243], v8, s[24:27], s40 offen offset:1024 sc1
    s_add_u32 s33, s39, 608
    v_mov_b32 v251, s33
    s_mov_b64 exec, 1
    ds_write_b32 v251, v253
    s_mov_b64 exec, -1
    s_waitcnt vmcnt(12)
    v_mfma_f32_32x32x16_bf16 v[16:31], v[200:203], v[144:147], v[16:31]
    v_mfma_f32_32x32x16_bf16 v[32:47], v[204:207], v[144:147], v[32:47]
    buffer_load_dwordx4 v[144:147], v8, s[24:27], s40 offen offset:2048 sc1
    s_waitcnt vmcnt(12)
    s_nop 0
    v_mfma_f32_32x32x16_bf16 v[16:31], v[208:211], v[148:151], v[16:31]
    v_mfma_f32_32x32x16_bf16 v[32:47], v[212:215], v[148:151], v[32:47]
    buffer_load_dwordx4 v[148:151], v8, s[24:27], s40 offen offset:3072 sc1
    s_waitcnt vmcnt(12)
    s_nop 0
    v_mfma_f32_32x32x16_bf16 v[16:31], v[160:163], v[152:155], v[16:31]
    v_mfma_f32_32x32x16_bf16 v[32:47], v[164:167], v[152:155], v[32:47]
    s_add_u32 s40, s40, 4096
    buffer_load_dwordx4 v[152:155], v8, s[24:27], s40 offen offset:0 sc1
    s_waitcnt vmcnt(12)
    s_nop 0
    v_mfma_f32_32x32x16_bf16 v[16:31], v[96:99], v[156:159], v[16:31]
    v_mfma_f32_32x32x16_bf16 v[32:47], v[100:103], v[156:159], v[32:47]
    buffer_load_dwordx4 v[156:159], v8, s[24:27], s40 offen offset:1024 sc1
    s_lshl_b32 s33, s58, 3
    s_add_u32 s33, s33, 162992
    v_and_b32 v250, 1, v1
    v_lshl_add_u32 v250, v250, 2, s33
    ds_read_b32 v251, v250
    s_waitcnt lgkmcnt(0)
    v_cmp_ne_u32_e64 vcc, 0, v251
    s_getpc_b64 s[62:63]
    s_cbranch_vccnz L_stub
    s_waitcnt vmcnt(12)
    v_mfma_f32_32x32x16_bf16 v[16:31], v[104:107], v[168:171], v[16:31]
    ds_read_b64_tr_b16 v[48:49], v6 offset:28672
    ds_read_b64_tr_b16 v[50:51], v6 offset:29184
    v_mfma_f32_32x32x16_bf16 v[32:47], v[108:111], v[168:171], v[32:47]
    ds_read_b64_tr_b16 v[52:53], v7 offset:28672
    ds_read_b64_tr_b16 v[54:55], v7 offset:29184
    buffer_load_dwordx4 v[168:171], v8, s[24:27], s40 offen offset:2048 sc1
    s_waitcnt vmcnt(12)
    s_nop 0
    v_mfma_f32_32x32x16_bf16 v[16:31], v[112:115], v[172:175], v[16:31]
    ds_read_b64_tr_b16 v[56:57], v6 offset:32768
    ds_read_b64_tr_b16 v[58:59], v6 offset:33280
    v_mfma_f32_32x32x16_bf16 v[32:47], v[116:119], v[172:175], v[32:47]
    ds_read_b64_tr_b16 v[60:61], v7 offset:32768
    ds_read_b64_tr_b16 v[62:63], v7 offset:33280
    buffer_load_dwordx4 v[172:175], v8, s[24:27], s40 offen offset:3072 sc1
    s_waitcnt vmcnt(12)
    s_nop 0
    v_mfma_f32_32x32x16_bf16 v[16:31], v[120:123], v[216:219], v[16:31]
    ds_read_b64_tr_b16 v[64:65], v6 offset:36864
    ds_read_b64_tr_b16 v[66:67], v6 offset:37376
    v_mfma_f32_32x32x16_bf16 v[32:47], v[124:127], v[216:219], v[32:47]
    ds_read_b64_tr_b16 v[68:69], v7 offset:36864
    ds_read_b64_tr_b16 v[70:71], v7 offset:37376
    s_add_u32 s40, s40, 4096
    buffer_load_dwordx4 v[216:219], v8, s[24:27], s40 offen offset:0 sc1
    s_waitcnt vmcnt(12) lgkmcnt(8)
    s_nop 0
    v_mfma_f32_32x32x16_bf16 v[16:31], v[48:51], v[220:223], v[16:31]
    ds_read_b64_tr_b16 v[72:73], v6 offset:40960
    ds_read_b64_tr_b16 v[74:75], v6 offset:41472
    v_mfma_f32_32x32x16_bf16 v[32:47], v[52:55], v[220:223], v[32:47]
    ds_read_b64_tr_b16 v[76:77], v7 offset:40960
    ds_read_b64_tr_b16 v[78:79], v7 offset:41472
    buffer_load_dwordx4 v[220:223], v8, s[24:27], s40 offen offset:1024 sc1
    s_waitcnt vmcnt(12) lgkmcnt(8)
    s_nop 0
    v_mfma_f32_32x32x16_bf16 v[16:31], v[56:59], v[224:227], v[16:31]
    ds_read_b64_tr_b16 v[80:81], v4 offset:12288
    ds_read_b64_tr_b16 v[82:83], v4 offset:12800
    v_mfma_f32_32x32x16_bf16 v[32:47], v[60:63], v[224:227], v[32:47]
    ds_read_b64_tr_b16 v[84:85], v5 offset:12288
    ds_read_b64_tr_b16 v[86:87], v5 offset:12800
    buffer_load_dwordx4 v[224:227], v8, s[24:27], s40 offen offset:2048 sc1
    s_waitcnt vmcnt(12) lgkmcnt(8)
    s_nop 0
    v_mfma_f32_32x32x16_bf16 v[16:31], v[64:67], v[228:231], v[16:31]
    ds_read_b64_tr_b16 v[88:89], v4 offset:16384
    ds_read_b64_tr_b16 v[90:91], v4 offset:16896
    v_mfma_f32_32x32x16_bf16 v[32:47], v[68:71], v[228:231], v[32:47]
    ds_read_b64_tr_b16 v[92:93], v5 offset:16384
    ds_read_b64_tr_b16 v[94:95], v5 offset:16896
    buffer_load_dwordx4 v[228:231], v8, s[24:27], s40 offen offset:3072 sc1
    s_waitcnt vmcnt(12) lgkmcnt(8)
    s_nop 0
    v_mfma_f32_32x32x16_bf16 v[16:31], v[72:75], v[232:235], v[16:31]
    ds_read_b64_tr_b16 v[176:177], v4 offset:20480
    ds_read_b64_tr_b16 v[178:179], v4 offset:20992
    v_mfma_f32_32x32x16_bf16 v[32:47], v[76:79], v[232:235], v[32:47]
    ds_read_b64_tr_b16 v[180:181], v5 offset:20480
    ds_read_b64_tr_b16 v[182:183], v5 offset:20992
    s_add_u32 s40, s40, 4096
    buffer_load_dwordx4 v[232:235], v8, s[24:27], s40 offen offset:0 sc1
    s_waitcnt vmcnt(12) lgkmcnt(8)
    s_nop 0
    v_mfma_f32_32x32x16_bf16 v[16:31], v[80:83], v[236:239], v[16:31]
    ds_read_b64_tr_b16 v[184:185], v4 offset:24576
    ds_read_b64_tr_b16 v[186:187], v4 offset:25088
    v_mfma_f32_32x32x16_bf16 v[32:47], v[84:87], v[236:239], v[32:47]
    ds_read_b64_tr_b16 v[188:189], v5 offset:24576
    ds_read_b64_tr_b16 v[190:191], v5 offset:25088
    buffer_load_dwordx4 v[236:239], v8, s[24:27], s40 offen offset:1024 sc1
    s_waitcnt vmcnt(12) lgkmcnt(8)
    s_nop 0
    v_mfma_f32_32x32x16_bf16 v[16:31], v[88:91], v[240:243], v[16:31]
    ds_read_b64_tr_b16 v[192:193], v4 offset:28672
    ds_read_b64_tr_b16 v[194:195], v4 offset:29184
    v_mfma_f32_32x32x16_bf16 v[32:47], v[92:95], v[240:243], v[32:47]
    ds_read_b64_tr_b16 v[196:197], v5 offset:28672
    ds_read_b64_tr_b16 v[198:199], v5 offset:29184
    buffer_load_dwordx4 v[240:243], v8, s[24:27], s40 offen offset:2048 sc1
    s_waitcnt vmcnt(12) lgkmcnt(8)
    s_nop 0
    v_mfma_f32_32x32x16_bf16 v[16:31], v[176:179], v[144:147], v[16:31]
    ds_read_b64_tr_b16 v[200:201], v4 offset:32768
    ds_read_b64_tr_b16 v[202:203], v4 offset:33280
    v_mfma_f32_32x32x16_bf16 v[32:47], v[180:183], v[144:147], v[32:47]
    ds_read_b64_tr_b16 v[204:205], v5 offset:32768
    ds_read_b64_tr_b16 v[206:207], v5 offset:33280
    buffer_load_dwordx4 v[144:147], v8, s[24:27], s40 offen offset:3072 sc1
    s_waitcnt vmcnt(12) lgkmcnt(8)
    s_nop 0
    v_mfma_f32_32x32x16_bf16 v[16:31], v[184:187], v[148:151], v[16:31]
    ds_read_b64_tr_b16 v[208:209], v4 offset:36864
    ds_read_b64_tr_b16 v[210:211], v4 offset:37376
    v_mfma_f32_32x32x16_bf16 v[32:47], v[188:191], v[148:151], v[32:47]
    ds_read_b64_tr_b16 v[212:213], v5 offset:36864
    ds_read_b64_tr_b16 v[214:215], v5 offset:37376
    s_add_u32 s40, s40, 4096
    buffer_load_dwordx4 v[148:151], v8, s[24:27], s40 offen offset:0 sc1
    s_lshl_b32 s33, s58, 3
    s_add_u32 s33, s33, 162704
    v_and_b32 v250, 1, v1
    v_lshl_add_u32 v250, v250, 2, s33
    ds_read_b32 v251, v250
    s_waitcnt lgkmcnt(0)
    v_cmp_ne_u32_e64 vcc, 0, v251
    s_getpc_b64 s[62:63]
    s_cbranch_vccnz L_stub
    s_waitcnt vmcnt(12)
    v_mfma_f32_32x32x16_bf16 v[16:31], v[192:195], v[152:155], v[16:31]
    ds_read_b64_tr_b16 v[160:161], v6 offset:0
    ds_read_b64_tr_b16 v[162:163], v6 offset:512
    v_mfma_f32_32x32x16_bf16 v[32:47], v[196:199], v[152:155], v[32:47]
    ds_read_b64_tr_b16 v[164:165], v7 offset:0
    ds_read_b64_tr_b16 v[166:167], v7 offset:512
    buffer_load_dwordx4 v[152:155], v8, s[24:27], s40 offen offset:1024 sc1
    s_waitcnt vmcnt(12)
    s_nop 0
    v_mfma_f32_32x32x16_bf16 v[16:31], v[200:203], v[156:159], v[16:31]
    ds_read_b64_tr_b16 v[96:97], v6 offset:4096
    ds_read_b64_tr_b16 v[98:99], v6 offset:4608
    v_mfma_f32_32x32x16_bf16 v[32:47], v[204:207], v[156:159], v[32:47]
    ds_read_b64_tr_b16 v[100:101], v7 offset:4096
    ds_read_b64_tr_b16 v[102:103], v7 offset:4608
    buffer_load_dwordx4 v[156:159], v8, s[24:27], s40 offen offset:2048 sc1
    s_waitcnt vmcnt(12)
    s_nop 0
    v_mfma_f32_32x32x16_bf16 v[16:31], v[208:211], v[168:171], v[16:31]
    ds_read_b64_tr_b16 v[104:105], v6 offset:8192
    ds_read_b64_tr_b16 v[106:107], v6 offset:8704
    v_mfma_f32_32x32x16_bf16 v[32:47], v[212:215], v[168:171], v[32:47]
    ds_read_b64_tr_b16 v[108:109], v7 offset:8192
    ds_read_b64_tr_b16 v[110:111], v7 offset:8704
    buffer_load_dwordx4 v[168:171], v8, s[24:27], s40 offen offset:3072 sc1
    s_waitcnt vmcnt(12) lgkmcnt(8)
    s_nop 0
    v_mfma_f32_32x32x16_bf16 v[16:31], v[160:163], v[172:175], v[16:31]
    ds_read_b64_tr_b16 v[112:113], v4 offset:40960
    ds_read_b64_tr_b16 v[114:115], v4 offset:41472
    v_mfma_f32_32x32x16_bf16 v[32:47], v[164:167], v[172:175], v[32:47]
    ds_read_b64_tr_b16 v[116:117], v5 offset:40960
    ds_read_b64_tr_b16 v[118:119], v5 offset:41472
    s_add_u32 s40, s40, 4096
    buffer_load_dwordx4 v[172:175], v8, s[24:27], s40 offen offset:0 sc1
    s_waitcnt vmcnt(12) lgkmcnt(8)
    s_nop 0
    v_mfma_f32_32x32x16_bf16 v[16:31], v[96:99], v[216:219], v[16:31]
    ds_read_b64_tr_b16 v[120:121], v4 offset:45056
    ds_read_b64_tr_b16 v[122:123], v4 offset:45568
    v_mfma_f32_32x32x16_bf16 v[32:47], v[100:103], v[216:219], v[32:47]
    ds_read_b64_tr_b16 v[124:125], v5 offset:45056
    ds_read_b64_tr_b16 v[126:127], v5 offset:45568
    buffer_load_dwordx4 v[216:219], v8, s[24:27], s40 offen offset:1024 sc1
    s_waitcnt vmcnt(12) lgkmcnt(8)
    s_nop 0
    v_mfma_f32_32x32x16_bf16 v[16:31], v[104:107], v[220:223], v[16:31]
    ds_read_b64_tr_b16 v[48:49], v4 offset:49152
    ds_read_b64_tr_b16 v[50:51], v4 offset:49664
    v_mfma_f32_32x32x16_bf16 v[32:47], v[108:111], v[220:223], v[32:47]
    ds_read_b64_tr_b16 v[52:53], v5 offset:49152
    ds_read_b64_tr_b16 v[54:55], v5 offset:49664
    buffer_load_dwordx4 v[220:223], v8, s[24:27], s40 offen offset:2048 sc1
    s_waitcnt vmcnt(12) lgkmcnt(8)
    s_nop 0
    v_mfma_f32_32x32x16_bf16 v[16:31], v[112:115], v[224:227], v[16:31]
    ds_read_b64_tr_b16 v[56:57], v4 offset:53248
    ds_read_b64_tr_b16 v[58:59], v4 offset:53760
    v_mfma_f32_32x32x16_bf16 v[32:47], v[116:119], v[224:227], v[32:47]
    ds_read_b64_tr_b16 v[60:61], v5 offset:53248
    ds_read_b64_tr_b16 v[62:63], v5 offset:53760
    s_waitcnt vmcnt(11) lgkmcnt(8)
    s_nop 0
    v_mfma_f32_32x32x16_bf16 v[16:31], v[120:123], v[228:231], v[16:31]
    ds_read_b64_tr_b16 v[64:65], v4 offset:57344
    ds_read_b64_tr_b16 v[66:67], v4 offset:57856
    v_mfma_f32_32x32x16_bf16 v[32:47], v[124:127], v[228:231], v[32:47]
    ds_read_b64_tr_b16 v[68:69], v5 offset:57344
    ds_read_b64_tr_b16 v[70:71], v5 offset:57856
    s_waitcnt vmcnt(10) lgkmcnt(8)
    s_nop 0
    v_mfma_f32_32x32x16_bf16 v[16:31], v[48:51], v[232:235], v[16:31]
    ds_read_b64_tr_b16 v[72:73], v4 offset:61440
    ds_read_b64_tr_b16 v[74:75], v4 offset:61952
    v_mfma_f32_32x32x16_bf16 v[32:47], v[52:55], v[232:235], v[32:47]
    ds_read_b64_tr_b16 v[76:77], v5 offset:61440
    ds_read_b64_tr_b16 v[78:79], v5 offset:61952
    s_waitcnt vmcnt(9) lgkmcnt(8)
    s_nop 0
    v_mfma_f32_32x32x16_bf16 v[16:31], v[56:59], v[236:239], v[16:31]
    ds_read_b64_tr_b16 v[80:81], v6 offset:12288
    ds_read_b64_tr_b16 v[82:83], v6 offset:12800
    v_mfma_f32_32x32x16_bf16 v[32:47], v[60:63], v[236:239], v[32:47]
    ds_read_b64_tr_b16 v[84:85], v7 offset:12288
    ds_read_b64_tr_b16 v[86:87], v7 offset:12800
    s_waitcnt vmcnt(8) lgkmcnt(8)
    s_nop 0
    v_mfma_f32_32x32x16_bf16 v[16:31], v[64:67], v[240:243], v[16:31]
    ds_read_b64_tr_b16 v[88:89], v6 offset:16384
    ds_read_b64_tr_b16 v[90:91], v6 offset:16896
    v_mfma_f32_32x32x16_bf16 v[32:47], v[68:71], v[240:243], v[32:47]
    ds_read_b64_tr_b16 v[92:93], v7 offset:16384
    ds_read_b64_tr_b16 v[94:95], v7 offset:16896
    s_waitcnt vmcnt(7) lgkmcnt(8)
    s_nop 0
    v_mfma_f32_32x32x16_bf16 v[16:31], v[72:75], v[144:147], v[16:31]
    ds_read_b64_tr_b16 v[176:177], v6 offset:20480
    ds_read_b64_tr_b16 v[178:179], v6 offset:20992
    v_mfma_f32_32x32x16_bf16 v[32:47], v[76:79], v[144:147], v[32:47]
    ds_read_b64_tr_b16 v[180:181], v7 offset:20480
    ds_read_b64_tr_b16 v[182:183], v7 offset:20992
    s_waitcnt vmcnt(6) lgkmcnt(8)
    s_nop 0
    v_mfma_f32_32x32x16_bf16 v[16:31], v[80:83], v[148:151], v[16:31]
    ds_read_b64_tr_b16 v[184:185], v6 offset:24576
    ds_read_b64_tr_b16 v[186:187], v6 offset:25088
    v_mfma_f32_32x32x16_bf16 v[32:47], v[84:87], v[148:151], v[32:47]
    ds_read_b64_tr_b16 v[188:189], v7 offset:24576
    ds_read_b64_tr_b16 v[190:191], v7 offset:25088
    s_waitcnt vmcnt(5) lgkmcnt(8)
    s_nop 0
    v_mfma_f32_32x32x16_bf16 v[16:31], v[88:91], v[152:155], v[16:31]
    ds_read_b64_tr_b16 v[192:193], v4 offset:0
    ds_read_b64_tr_b16 v[194:195], v4 offset:512
    v_mfma_f32_32x32x16_bf16 v[32:47], v[92:95], v[152:155], v[32:47]
    ds_read_b64_tr_b16 v[196:197], v5 offset:0
    ds_read_b64_tr_b16 v[198:199], v5 offset:512
    s_waitcnt vmcnt(4) lgkmcnt(8)
    s_nop 0
    v_mfma_f32_32x32x16_bf16 v[16:31], v[176:179], v[156:159], v[16:31]
    ds_read_b64_tr_b16 v[200:201], v4 offset:4096
    ds_read_b64_tr_b16 v[202:203], v4 offset:4608
    v_mfma_f32_32x32x16_bf16 v[32:47], v[180:183], v[156:159], v[32:47]
    ds_read_b64_tr_b16 v[204:205], v5 offset:4096
    ds_read_b64_tr_b16 v[206:207], v5 offset:4608
    s_waitcnt vmcnt(3) lgkmcnt(8)
    s_nop 0
    v_mfma_f32_32x32x16_bf16 v[16:31], v[184:187], v[168:171], v[16:31]
    ds_read_b64_tr_b16 v[208:209], v4 offset:8192
    ds_read_b64_tr_b16 v[210:211], v4 offset:8704
    v_mfma_f32_32x32x16_bf16 v[32:47], v[188:191], v[168:171], v[32:47]
    ds_read_b64_tr_b16 v[212:213], v5 offset:8192
    ds_read_b64_tr_b16 v[214:215], v5 offset:8704
    s_waitcnt vmcnt(2) lgkmcnt(8)
    v_mfma_f32_32x32x16_bf16 v[16:31], v[192:195], v[172:175], v[16:31]
    v_and_b32 v250, 3, v1
    v_lshlrev_b32_e64 v250, 2, v250
    v_add_u32 v250, 162864, v250
    ds_read_b32 v251, v250
    v_mfma_f32_32x32x16_bf16 v[32:47], v[196:199], v[172:175], v[32:47]
    s_waitcnt vmcnt(1) lgkmcnt(5)
    v_mfma_f32_32x32x16_bf16 v[16:31], v[200:203], v[216:219], v[16:31]
    v_mfma_f32_32x32x16_bf16 v[32:47], v[204:207], v[216:219], v[32:47]
    s_waitcnt vmcnt(0) lgkmcnt(0)
    v_mfma_f32_32x32x16_bf16 v[16:31], v[208:211], v[220:223], v[16:31]
    v_cmp_ne_u32_e64 vcc, 0, v251
    v_mfma_f32_32x32x16_bf16 v[32:47], v[212:215], v[220:223], v[32:47]
    s_getpc_b64 s[62:63]
    s_cbranch_vccnz L_stub
    s_nop 7
    s_nop 0
    ds_write_b128 v10, v[16:19] offset:0
    ds_write_b128 v10, v[20:23] offset:32
    ds_write_b128 v10, v[24:27] offset:64
    ds_write_b128 v10, v[28:31] offset:96
    ds_write_b128 v10, v[32:35] offset:128
    ds_write_b128 v10, v[36:39] offset:160
    ds_write_b128 v10, v[40:43] offset:192
    ds_write_b128 v10, v[44:47] offset:224
    s_branch L_final
    .p2align 6
L_spare_ld:
    s_mov_b64 s[8:9], s[64:65]
    s_mul_i32 s59, s57, 16896
    s_add_u32 s59, s59, 110912
    s_lshl_b32 s60, s57, 4
    s_add_u32 s60, s60, 144704
    s_mov_b64 s[20:21], s[88:89]
    s_mov_b32 s22, 1409024
    s_mov_b32 s23, 0x20000
    s_mov_b64 s[24:25], s[94:95]
    s_mov_b32 s26, 268435456
    s_mov_b32 s27, 0x20000
    s_mov_b64 s[28:29], s[90:91]
    s_nop 0
    s_mov_b32 s30, 2097152
    s_mov_b32 s31, 0x20000
    v_mov_b32 v252, 0x7ff00000
    v_mov_b32 v253, 0
    s_barrier
    v_lshlrev_b32_e64 v24, 7, v1
    s_lshl_b32 s32, s53, 1
    s_add_u32 s32, s32, s57
    s_mul_i32 s32, s32, 2816
    s_mov_b64 exec, 0x3fffff
    buffer_load_dword v26, v24, s[20:23], s32 offen
    s_mov_b64 exec, -1
    v_lshlrev_b32_e64 v18, 10, v1
    s_and_b32 s42, s49, 1
    s_mul_i32 s42, s42, 704512
    s_lshl_b32 s43, s57, 16
    s_add_u32 s42, s42, s43
    s_add_u32 s42, s42, 384
    buffer_load_dword v20, v18, s[20:23], s42 offen
    s_add_u32 s42, s42, 0x20000
    s_waitcnt vmcnt(1)
    buffer_load_dword v20, v18, s[20:23], s42 offen
    s_add_u32 s42, s42, 0x20000
    s_waitcnt vmcnt(1)
    buffer_load_dword v20, v18, s[20:23], s42 offen
    s_add_u32 s42, s42, 0x20000
    s_waitcnt vmcnt(1)
    buffer_load_dword v20, v18, s[20:23], s42 offen
    s_add_u32 s42, s42, 0x20000
    s_waitcnt vmcnt(1)
    v_lshlrev_b32 v18, 7, v1
    s_and_b32 s42, s49, 1
    s_mul_i32 s42, s42, 704512
    s_mul_i32 s43, s57, 8192
    s_add_u32 s42, s42, s43
    s_nop 0
    s_add_u32 s42, s42, 688128
    buffer_load_dword v20, v18, s[20:23], s42 offen
    s_sub_u32 s42, s42, 16384
    s_waitcnt vmcnt(1)
    buffer_load_dword v20, v18, s[20:23], s42 offen
    s_sub_u32 s42, s42, 16384
    s_waitcnt vmcnt(1)
    buffer_load_dword v20, v18, s[20:23], s42 offen
    s_sub_u32 s42, s42, 16384
    s_waitcnt vmcnt(1)
    buffer_load_dword v20, v18, s[20:23], s42 offen
    s_sub_u32 s42, s42, 16384
    s_waitcnt vmcnt(1)
    buffer_load_dword v20, v18, s[20:23], s42 offen
    s_sub_u32 s42, s42, 16384
    s_waitcnt vmcnt(1)
    buffer_load_dword v20, v18, s[20:23], s42 offen
    s_sub_u32 s42, s42, 16384
    s_waitcnt vmcnt(1)
    buffer_load_dword v20, v18, s[20:23], s42 offen
    s_sub_u32 s42, s42, 16384
    s_waitcnt vmcnt(1)
    buffer_load_dword v20, v18, s[20:23], s42 offen
    s_sub_u32 s42, s42, 16384
    s_waitcnt vmcnt(1)
    buffer_load_dword v20, v18, s[20:23], s42 offen
    s_sub_u32 s42, s42, 16384
    s_waitcnt vmcnt(1)
    buffer_load_dword v20, v18, s[20:23], s42 offen
    s_sub_u32 s42, s42, 16384
    s_waitcnt vmcnt(1)
    buffer_load_dword v20, v18, s[20:23], s42 offen
    s_sub_u32 s42, s42, 16384
    s_waitcnt vmcnt(1)
    s_lshl_b32 s40, s57, 2
    s_add_u32 s40, s40, 162112
    v_lshl_add_u32 v22, v1, 5, s40
    s_mov_b64 exec, 0x3fff
    ds_write_b32 v22, v253
    s_mov_b64 exec, -1
    s_waitcnt vmcnt(0)
    s_lshl_b32 s40, s57, 2
    s_nop 0
    s_add_u32 s40, s40, 162112
    v_lshl_add_u32 v18, v1, 5, s40
    s_mov_b64 exec, 0xffff
    ds_write_b32 v18, v253
    s_mov_b64 exec, -1
    s_branch L_fetch
L_srs:
    s_sleep 6
    s_load_dwordx16 s[64:79], s[100:101], s36 glc
    s_add_u32 s32, s36, 64
    s_load_dwordx16 s[80:95], s[100:101], s32 glc
    s_add_u32 s46, s46, 1
    s_cmp_lt_u32 s46, 30000
    s_cbranch_scc1 L_sps
    s_waitcnt lgkmcnt(0)
    s_branch L_sos
L_k5:
    s_and_b32 s32, s49, 30
    s_cmp_lg_u32 s32, 28
    s_cbranch_scc1 L_k3
    v_lshlrev_b32_e64 v244, 7, v1
    s_and_b32 s34, s49, 1
    s_mul_i32 s34, s34, 704512
    s_waitcnt vmcnt(0)
    s_branch L_k3
L_spare_g:
    s_waitcnt lgkmcnt(0)
    s_cmp_lt_u32 s3, 2
    s_cbranch_scc1 L_ls_100001
    s_nop 0
    buffer_store_dwordx4 v[48:51], v241, s[24:27], s66 offen offset:0 sc1
    buffer_store_dwordx4 v[52:55], v241, s[24:27], s66 offen offset:1024 sc1
    buffer_store_dwordx4 v[56:59], v241, s[24:27], s66 offen offset:2048 sc1
    buffer_store_dwordx4 v[60:63], v241, s[24:27], s66 offen offset:3072 sc1
    buffer_store_dwordx2 v[232:233], v234, s[24:27], s70 offen sc1
    s_mov_b64 exec, s[68:69]
    buffer_store_dwordx4 v[236:239], v240, s[24:27], s67 offen sc1
    s_mov_b64 exec, 1
    buffer_load_dword v252, s[8:11], 0 offen offset:960 lds
    s_mov_b64 exec, -1
L_ls_100001:
    v_and_b32 v2, 3, v1
    v_lshlrev_b32_e64 v2, 2, v2
    v_add_u32 v2, 162608, v2
    v_lshlrev_b32 v47, 4, v1
    s_mul_i32 s32, s55, 37
    s_lshr_b32 s32, s32, 8
    s_mul_i32 s32, s32, 7
    s_sub_u32 s32, s55, s32
    s_add_u32 s32, s32, 4
    s_and_b32 s32, s32, 7
    s_lshl_b32 s32, s32, 7
    s_add_u32 s32, s32, 20971136
    v_lshrrev_b32_e64 v42, 3, v1
    v_cmp_eq_u32 s[6:7], 3, v42
    v_add_u32 v42, s32, v47
    s_nop 0
    v_cndmask_b32 v47, v47, v42, s[6:7]
    v_bfe_u32 v42, v1, 2, 2
    v_lshrrev_b32_e64 v43, 5, v1
    v_lshl_add_u32 v43, v43, 3, v42
    v_lshlrev_b32 v43, 7, v43
    v_lshrrev_b32 v42, 1, v42
    v_lshlrev_b32_e64 v42, 6, v42
    v_bfe_u32 v44, v1, 4, 1
    v_lshlrev_b32 v44, 5, v44
    v_and_b32 v45, 3, v1
    v_lshl_add_u32 v44, v45, 3, v44
    v_add3_u32 v42, v42, v43, v44
    s_lshl_b32 s32, s58, 11
    v_add_u32 v38, s32, v42
    v_xor_b32_e64 v39, 64, v38
    v_add_u32 v40, 0x10000, v38
    v_add_u32 v41, 0x10000, v39
    s_lshl_b32 s32, s55, 1
    s_add_u32 s32, s32, s57
    s_mul_i32 s32, s32, 86
    s_mul_i32 s33, s58, 43
    s_add_u32 s32, s32, s33
    s_lshl_b32 s32, s32, 10
    s_add_u32 s40, s32, 4194304
    v_lshrrev_b32 v42, 3, v1
    v_lshlrev_b32 v42, 10, v42
    v_lshrrev_b32 v43, 2, v1
    v_and_b32 v43, 4, v43
    v_and_b32 v44, 7, v1
    v_xor_b32_e64 v43, v43, v44
    v_lshl_add_u32 v46, v43, 4, v42
    s_mul_i32 s44, s58, 704512
    s_lshl_b32 s32, s56, 7
    s_add_u32 s44, s44, s32
    s_lshl_b32 s32, s57, 13
    s_add_u32 s44, s44, s32
    s_add_u32 s44, s44, 245760
    s_lshl_b32 s45, s58, 11
    s_lshl_b32 s32, s57, 10
    s_add_u32 s45, s45, s32
    s_lshl_b32 s32, s55, 1
    s_add_u32 s32, s32, s58
    s_lshl_b32 s32, s32, 8
    s_add_u32 s47, s32, 16384
    s_mov_b64 s[100:101], s[94:95]
    v_mov_b32 v250, 162916
    ds_read_b32 v251, v250
    s_waitcnt lgkmcnt(0)
    v_cmp_ne_u32_e64 vcc, 0, v251
    s_getpc_b64 s[62:63]
    s_cbranch_vccnz L_stub
    v_mov_b32 v250, 163008
    ds_read_b64 v[250:251], v250
    s_waitcnt lgkmcnt(0)
    v_readfirstlane_b32 s4, v250
    v_readfirstlane_b32 s5, v251
    s_nop 1
    s_lshl_b32 s37, s53, 2
    s_add_u32 s37, s37, s3
    s_lshl_b32 s37, s37, 6
    s_add_u32 s37, s37, 0x20000
    s_mov_b32 s36, 0
    v_lshl_add_u32 v24, v1, 5, s39
    s_mov_b64 exec, 0xffff
    ds_write_b32 v24, v253
    s_mov_b64 exec, -1
    s_lshr_b32 s32, s3, 1
    s_lshl_b32 s33, s55, 2
    s_add_u32 s32, s32, s33
    s_and_b32 s33, s3, 1
    s_lshl_b32 s34, s56, 1
    s_add_u32 s33, s33, s34
    s_lshl_b32 s33, s33, 6
    s_lshl_b32 s34, s32, 14
    s_add_u32 s33, s33, s34
    v_and_b32 v10, 15, v1
    v_lshlrev_b32 v10, 10, v10
    v_and_b32_e64 v11, 48, v1
    v_add3_u32 v249, v10, v11, s33
    buffer_load_dwordx4 v[244:247], v249, s[8:11], 0 offen
    v_bfe_u32 v10, v1, 3, 1
    v_mul_u32_u24 v10, 8320, v10
    v_and_b32_e64 v11, 7, v1
    v_lshl_add_u32 v10, v11, 3, v10
    s_mul_i32 s32, s32, 16640
    s_add_u32 s32, s32, 1056772
    buffer_load_dword v248, v10, s[24:27], s32 offen sc1
    s_branch L_e1end
L_e1end:
    s_add_u32 s32, s39, 512
    v_mov_b32_e64 v251, s32
    s_mov_b64 exec, 1
    ds_write_b32 v251, v253
    s_mov_b64 exec, -1
    v_mov_b32 v250, v2
    ds_read_b32 v251, v250
    s_nop 7
    s_branch L_e2end
L_srh:
    s_sleep 6
    s_load_dwordx16 s[64:79], s[100:101], s47 glc
    s_add_u32 s32, s47, 64
    s_load_dwordx16 s[80:95], s[100:101], s32 glc
    s_add_u32 s46, s46, 1
    s_cmp_lt_u32 s46, 30000
    s_cbranch_scc1 L_sph
    s_waitcnt lgkmcnt(0)
    s_branch L_soh
L_codeend:
.section .rodata,"a"
.p2align 6
.amdhsa_kernel recurrent_scan__ssm_conv_s4__glu_gated_glu__prompt_kernel
  .amdhsa_next_free_vgpr 256
  .amdhsa_next_free_sgpr 102
  .amdhsa_accum_offset 256
  .amdhsa_group_segment_fixed_size 0
  .amdhsa_kernarg_size 128
  .amdhsa_user_sgpr_count 2
  .amdhsa_user_sgpr_kernarg_segment_ptr 1
  .amdhsa_system_sgpr_workgroup_id_x 1
.end_amdhsa_kernel
```
